```python
import torch

def _softmax(x, axis=-1):
    return torch.softmax(x, dim=axis)
def _gelu(x):
    return torch.nn.functional.gelu(x, approximate="tanh")
def _silu(x):
    return torch.nn.functional.silu(x)
def _sigmoid(x):
    return torch.sigmoid(x)
def _layernorm(x, axis=-1, eps=1e-5):
    m = x.mean(dim=axis, keepdim=True)
    v = x.var(dim=axis, keepdim=True, unbiased=False)
    return (x - m) / torch.sqrt(v + eps)
def _scatter_add(tgt, idx, src, axis=0):
    return tgt.clone().index_add_(axis, idx, src)
def _segment_sum(src, seg, n):
    out = torch.zeros((n,) + src.shape[1:], dtype=src.dtype)
    return out.index_add_(0, seg, src)
def _pad(x, pw):
    flat = tuple(v for pair in reversed(pw) for v in pair)
    return torch.nn.functional.pad(x, flat)

kernel_name = 'concat_heads__gqa_block_cached__gqa_block_cached__near_ridge'

def setup_inputs():

    _w = (lambda a: (lambda t: t.to(torch.bfloat16) if t.is_floating_point() else t)(torch.as_tensor(a)))
    def _A_setup():
        B, Sq, D = 8, 208, 640
        Hq, Hkv, Sk, Dh = 32, 32, 1024, 128
        assert Hq % Hkv == 0, (Hq, Hkv)
        return {
            "x": _w((lambda *s: torch.randn(*s, dtype=torch.bfloat16) * 0.8)(B, Sq, D)),
            "k_cache": _w((lambda *s: torch.randn(*s, dtype=torch.bfloat16) * 0.8)(B, Hkv, Sk, Dh)),
            "v_cache": _w((lambda *s: torch.randn(*s, dtype=torch.bfloat16) * 0.05)(B, Hkv, Sk, Dh)),
            "wq": _w((lambda *s: torch.randn(*s, dtype=torch.bfloat16) * 0.8)(D, Hq * Dh) * (D ** -0.5)),
            "wo": _w((lambda *s: torch.randn(*s, dtype=torch.bfloat16) * 0.05)(Hq * Dh, D) * ((Hq * Dh) ** -0.5)),
        }
    _A_in = _A_setup()

    def _B_setup():
        B, Sq, D = 8, 208, 640
        Hq, Hkv, Sk, Dh = 32, 32, 1024, 128
        assert Hq % Hkv == 0, (Hq, Hkv)
        return {
            "x": _w((lambda *s: torch.randn(*s, dtype=torch.bfloat16) * 0.8)(B, Sq, D)),
            "k_cache": _w((lambda *s: torch.randn(*s, dtype=torch.bfloat16) * 0.8)(B, Hkv, Sk, Dh)),
            "v_cache": _w((lambda *s: torch.randn(*s, dtype=torch.bfloat16) * 0.05)(B, Hkv, Sk, Dh)),
            "wq": _w((lambda *s: torch.randn(*s, dtype=torch.bfloat16) * 0.8)(D, Hq * Dh) * (D ** -0.5)),
            "wo": _w((lambda *s: torch.randn(*s, dtype=torch.bfloat16) * 0.05)(Hq * Dh, D) * ((Hq * Dh) ** -0.5)),
        }
    _B_in = _B_setup()

    return {
        "A_x": _A_in["x"],
        "A_k_cache": _A_in["k_cache"],
        "A_v_cache": _A_in["v_cache"],
        "A_wq": _A_in["wq"],
        "A_wo": _A_in["wo"],
        "B_x": _B_in["x"],
        "B_k_cache": _B_in["k_cache"],
        "B_v_cache": _B_in["v_cache"],
        "B_wq": _B_in["wq"],
        "B_wo": _B_in["wo"],
    }

def reference(A_x, A_k_cache, A_v_cache, A_wq, A_wo, B_x, B_k_cache, B_v_cache, B_wq, B_wo):
    def _A_ref(x, k_cache, v_cache, wq, wo):
        B, Sq, D = x.shape
        Hq, Dh = 32, 128
        Hkv = k_cache.shape[1]
        rep = Hq // Hkv
        q = (lambda x, *d: x.permute(*d))((x @ wq).reshape(B, Sq, Hq, Dh), 0, 2, 1, 3)
        k = (lambda x, n, axis: torch.repeat_interleave(x, n, dim=axis))(k_cache, rep, axis=1)
        v = (lambda x, n, axis: torch.repeat_interleave(x, n, dim=axis))(v_cache, rep, axis=1)
        scores = torch.einsum("bhqd,bhkd->bhqk", q, k) * (Dh ** -0.5)
        p = _softmax(scores, axis=-1)
        o = torch.einsum("bhqk,bhkd->bhqd", p, v)
        return (lambda x, *d: x.permute(*d))(o, 0, 2, 1, 3).reshape(B, Sq, Hq * Dh) @ wo

    def _B_ref(x, k_cache, v_cache, wq, wo):
        B, Sq, D = x.shape
        Hq, Dh = 32, 128
        Hkv = k_cache.shape[1]
        rep = Hq // Hkv
        q = (lambda x, *d: x.permute(*d))((x @ wq).reshape(B, Sq, Hq, Dh), 0, 2, 1, 3)
        k = (lambda x, n, axis: torch.repeat_interleave(x, n, dim=axis))(k_cache, rep, axis=1)
        v = (lambda x, n, axis: torch.repeat_interleave(x, n, dim=axis))(v_cache, rep, axis=1)
        scores = torch.einsum("bhqd,bhkd->bhqk", q, k) * (Dh ** -0.5)
        p = _softmax(scores, axis=-1)
        o = torch.einsum("bhqk,bhkd->bhqd", p, v)
        return (lambda x, *d: x.permute(*d))(o, 0, 2, 1, 3).reshape(B, Sq, Hq * Dh) @ wo

    a = _A_ref(A_x, A_k_cache, A_v_cache, A_wq, A_wo)
    b = _B_ref(B_x, B_k_cache, B_v_cache, B_wq, B_wo)
    return torch.concatenate([a, b], axis=-1)
```

```asm
; @launch kernel=attn_kernel grid=(256,1,1) block=(256,1,1) lds=163840
; @launch kernel=oproj_kernel grid=(256,1,1) block=(256,1,1) lds=143360
.amdgcn_target "amdgcn-amd-amdhsa--gfx950"
.text
.globl attn_kernel
.p2align 8
.type attn_kernel,@function
attn_kernel:
    s_cmp_ge_u32 s2, 256
    s_cbranch_scc1 L_at_done
    s_load_dwordx16 s[64:79], s[0:1], 0
    s_load_dwordx8 s[80:87], s[0:1], 64
    s_load_dwordx2 s[88:89], s[0:1], 96
    v_and_b32 v1, 63, v0
    v_lshrrev_b32 v7, 6, v0
    s_and_b32 s9, s2, 7
    v_readfirstlane_b32 s3, v7
    s_lshr_b32 s6, s9, 2
    s_lshr_b32 s10, s2, 3
    s_lshr_b32 s4, s3, 1
    s_and_b32 s5, s3, 1
    s_and_b32 s8, s9, 3
    s_lshl_b32 s8, s8, 2
    s_and_b32 s11, s10, 3
    s_add_u32 s8, s8, s11
    s_lshr_b32 s7, s10, 2
    v_lshrrev_b32 v7, 4, v1
    v_and_b32 v8, 15, v1
    v_lshrrev_b32 v9, 2, v8
    v_and_b32 v10, 3, v1
    v_lshrrev_b32 v11, 3, v1
    v_mul_u32_u24 v11, 1280, v11
    v_and_b32 v12, 7, v1
    v_lshlrev_b32 v13, 1, v7
    v_xor_b32 v12, v12, v13
    v_lshl_add_u32 v250, v12, 4, v11
    v_lshlrev_b32 v11, 16, v7
    v_lshl_add_u32 v15, v8, 4, v11
    v_lshlrev_b32 v11, 4, v1
    s_mul_i32 s48, s3, 71680
    s_mul_i32 s49, s3, 7168
    s_lshl_b32 s50, s5, 18
    s_lshl_b32 s10, s4, 8
    s_add_u32 s50, s50, s10
    s_mul_i32 s51, s3, 8448
    s_mul_i32 s53, s3, 8704
    s_waitcnt lgkmcnt(0)
    s_cmp_eq_u32 s6, 0
    s_cselect_b32 s16, s64, s74
    s_cselect_b32 s17, s65, s75
    s_cselect_b32 s20, s70, s80
    s_cselect_b32 s21, s71, s81
    s_cselect_b32 s44, s66, s76
    s_cselect_b32 s45, s67, s77
    s_cselect_b32 s46, s68, s78
    s_cselect_b32 s47, s69, s79
    s_mul_i32 s10, s7, 266240
    s_add_u32 s16, s16, s10
    s_addc_u32 s17, s17, 0
    s_and_b32 s17, s17, 0xffff
    s_mov_b32 s18, 266240
    s_mov_b32 s19, 0x20000
    s_lshl_b32 s10, s8, 9
    s_add_u32 s20, s20, s10
    s_addc_u32 s21, s21, 0
    s_and_b32 s21, s21, 0xffff
    s_sub_u32 s22, 5242880, s10
    s_mov_b32 s23, 0x20000
    s_cmp_eq_u32 s3, 3
    s_cbranch_scc1 L_xs1
    s_add_u32 m0, s49, 46080
    s_add_u32 s52, s48, 51200
    buffer_load_dwordx4 v250, s[16:19], s52 offen  lds
    s_add_u32 m0, s49, 47104
    s_add_u32 s52, s48, 61440
    buffer_load_dwordx4 v250, s[16:19], s52 offen  lds
L_xs1:
    s_add_u32 m0, s53, 67584
    s_add_u32 s52, s50, 0
    buffer_load_dwordx4 v15, s[20:23], s52 offen  lds
    s_add_u32 m0, s53, 68672
    s_add_u32 s52, s50, 8192
    buffer_load_dwordx4 v15, s[20:23], s52 offen  lds
    s_add_u32 m0, s53, 69760
    s_add_u32 s52, s50, 16384
    buffer_load_dwordx4 v15, s[20:23], s52 offen  lds
    s_add_u32 m0, s53, 70848
    s_add_u32 s52, s50, 24576
    buffer_load_dwordx4 v15, s[20:23], s52 offen  lds
    s_add_u32 m0, s53, 71936
    s_add_u32 s52, s50, 32768
    buffer_load_dwordx4 v15, s[20:23], s52 offen  lds
    s_add_u32 m0, s53, 73024
    s_add_u32 s52, s50, 40960
    buffer_load_dwordx4 v15, s[20:23], s52 offen  lds
    s_add_u32 m0, s53, 74112
    s_add_u32 s52, s50, 49152
    buffer_load_dwordx4 v15, s[20:23], s52 offen  lds
    s_add_u32 m0, s53, 75200
    s_add_u32 s52, s50, 57344
    buffer_load_dwordx4 v15, s[20:23], s52 offen  lds
    s_add_u32 m0, s49, 40960
    s_add_u32 s52, s48, 0
    buffer_load_dwordx4 v250, s[16:19], s52 offen  lds
    s_add_u32 m0, s49, 41984
    s_add_u32 s52, s48, 10240
    buffer_load_dwordx4 v250, s[16:19], s52 offen  lds
    s_add_u32 m0, s49, 43008
    s_add_u32 s52, s48, 20480
    buffer_load_dwordx4 v250, s[16:19], s52 offen  lds
    s_add_u32 m0, s49, 44032
    s_add_u32 s52, s48, 30720
    buffer_load_dwordx4 v250, s[16:19], s52 offen  lds
    s_add_u32 m0, s49, 45056
    s_add_u32 s52, s48, 40960
    buffer_load_dwordx4 v250, s[16:19], s52 offen  lds
    s_cmp_eq_u32 s3, 3
    s_cbranch_scc1 L_xs2
    s_add_u32 m0, s49, 107520
    s_add_u32 s52, s48, 51328
    buffer_load_dwordx4 v250, s[16:19], s52 offen  lds
    s_add_u32 m0, s49, 108544
    s_add_u32 s52, s48, 61568
    buffer_load_dwordx4 v250, s[16:19], s52 offen  lds
L_xs2:
    s_add_u32 m0, s53, 129024
    s_add_u32 s52, s50, 524288
    buffer_load_dwordx4 v15, s[20:23], s52 offen  lds
    s_add_u32 m0, s53, 130112
    s_add_u32 s52, s50, 532480
    buffer_load_dwordx4 v15, s[20:23], s52 offen  lds
    s_add_u32 m0, s53, 131200
    s_add_u32 s52, s50, 540672
    buffer_load_dwordx4 v15, s[20:23], s52 offen  lds
    s_add_u32 m0, s53, 132288
    s_add_u32 s52, s50, 548864
    buffer_load_dwordx4 v15, s[20:23], s52 offen  lds
    s_add_u32 m0, s53, 133376
    s_add_u32 s52, s50, 557056
    buffer_load_dwordx4 v15, s[20:23], s52 offen  lds
    s_add_u32 m0, s53, 134464
    s_add_u32 s52, s50, 565248
    buffer_load_dwordx4 v15, s[20:23], s52 offen  lds
    s_add_u32 m0, s53, 135552
    s_add_u32 s52, s50, 573440
    buffer_load_dwordx4 v15, s[20:23], s52 offen  lds
    s_add_u32 m0, s53, 136640
    s_add_u32 s52, s50, 581632
    buffer_load_dwordx4 v15, s[20:23], s52 offen  lds
    s_add_u32 m0, s49, 102400
    s_add_u32 s52, s48, 128
    buffer_load_dwordx4 v250, s[16:19], s52 offen  lds
    s_add_u32 m0, s49, 103424
    s_add_u32 s52, s48, 10368
    buffer_load_dwordx4 v250, s[16:19], s52 offen  lds
    s_add_u32 m0, s49, 104448
    s_add_u32 s52, s48, 20608
    buffer_load_dwordx4 v250, s[16:19], s52 offen  lds
    s_add_u32 m0, s49, 105472
    s_add_u32 s52, s48, 30848
    buffer_load_dwordx4 v250, s[16:19], s52 offen  lds
    s_add_u32 m0, s49, 106496
    s_add_u32 s52, s48, 41088
    buffer_load_dwordx4 v250, s[16:19], s52 offen  lds
    s_lshr_b32 s10, s2, 7
    s_and_b32 s11, s2, 127
    s_cmp_eq_u32 s10, 0
    s_cselect_b32 s28, s72, s82
    s_cselect_b32 s29, s73, s83
    s_mul_i32 s11, s11, 40960
    s_add_u32 s28, s28, s11
    s_addc_u32 s29, s29, 0
    s_and_b32 s29, s29, 0xffff
    s_mov_b32 s30, 40960
    s_mov_b32 s31, 0x20000
    s_mul_i32 s10, s3, 10240
    s_mov_b32 s54, s10
    s_and_b32 s10, s8, 3
    s_mul_i32 s10, s10, 66560
    s_mul_i32 s11, s3, 16640
    s_add_u32 s10, s10, s11
    v_lshlrev_b32 v12, 7, v1
    buffer_load_dword v56, v12, s[16:19], s10 offen
    s_add_u32 s10, s10, 8192
    buffer_load_dword v57, v12, s[16:19], s10 offen
    s_add_u32 s10, s10, 256
    buffer_load_dword v58, v12, s[16:19], s10 offen
    v_lshrrev_b32 v13, 2, v1
    v_lshlrev_b32 v13, 13, v13
    v_lshl_add_u32 v13, v10, 7, v13
    s_mul_i32 s10, s7, 655360
    s_mul_i32 s11, s3, 163840
    s_add_u32 s10, s10, s11
    buffer_load_dword v59, v13, s[20:23], s10 offen
    s_add_u32 s10, s10, 32768
    buffer_load_dword v60, v13, s[20:23], s10 offen
    s_mul_i32 s11, s2, 40960
    s_add_u32 s11, s11, 27262976
    s_add_u32 s32, s88, s11
    s_addc_u32 s33, s89, 0
    s_and_b32 s33, s33, 0xffff
    s_mov_b32 s34, 40960
    s_mov_b32 s35, 0x20000
    s_cmp_lt_u32 s3, 2
    s_cselect_b32 s12, s44, s46
    s_cselect_b32 s13, s45, s47
    s_lshl_b32 s10, s7, 5
    s_lshl_b32 s11, s8, 1
    s_add_u32 s10, s10, s11
    s_add_u32 s11, s10, s5
    s_lshl_b32 s11, s11, 18
    s_add_u32 s12, s12, s11
    s_addc_u32 s13, s13, 0
    s_and_b32 s13, s13, 0xffff
    s_mov_b32 s14, 262144
    s_mov_b32 s15, 0x20000
    s_lshl_b32 s11, s6, 8
    s_add_u32 s10, s10, s11
    s_add_u32 s10, s10, s4
    s_mul_i32 s10, s10, 53248
    s_add_u32 s24, s88, s10
    s_addc_u32 s25, s89, 0
    s_and_b32 s25, s25, 0xffff
    s_mov_b32 s26, 53248
    s_mov_b32 s27, 0x20000
    s_mov_b32 s37, 0
    s_mov_b32 s38, s51
    s_mov_b32 s41, s51
    s_add_u32 s42, s51, 135168
    s_mov_b32 s43, 0x3e0293ee
    s_mov_b32 s44, 0x3e0293ee
    s_mov_b32 s45, 0x3e0293ee
    v_lshlrev_b32 v12, 11, v7
    v_lshl_add_u32 v6, v8, 4, v12
    v_and_b32 v12, 7, v8
    v_mul_u32_u24 v12, 1056, v12
    v_lshrrev_b32 v13, 3, v8
    v_lshl_add_u32 v12, v13, 8, v12
    v_lshl_add_u32 v12, v7, 4, v12
    s_mul_i32 s10, s4, 8448
    v_add_u32 v4, s10, v12
    v_and_b32 v12, 1, v7
    v_lshl_add_u32 v12, v12, 2, v9
    v_mul_u32_u24 v12, 1056, v12
    v_lshrrev_b32 v13, 1, v7
    v_lshl_add_u32 v12, v13, 8, v12
    v_lshl_add_u32 v12, v10, 3, v12
    s_add_u32 s10, s10, 16896
    v_add_u32 v5, s10, v12
    v_lshrrev_b32 v12, 1, v8
    v_and_b32 v12, 3, v12
    v_lshlrev_b32 v12, 1, v12
    v_xor_b32 v12, v7, v12
    v_lshlrev_b32 v12, 4, v12
    v_lshl_add_u32 v12, v8, 7, v12
    v_xor_b32 v13, 64, v12
    s_mul_i32 s10, s5, 12288
    s_add_u32 s11, s10, 40960
    v_add_u32 v240, s11, v12
    v_add_u32 v241, s11, v13
    v_add_u32 v244, 65536, v12
    v_add_u32 v245, 65536, v13
    s_add_u32 s11, s10, 102400
    v_add_u32 v242, s11, v12
    v_add_u32 v243, s11, v13
    v_add_u32 v246, 126976, v12
    v_add_u32 v247, 126976, v13
    v_mul_u32_u24 v12, 1088, v9
    v_lshl_add_u32 v12, v7, 8, v12
    v_lshl_add_u32 v12, v10, 4, v12
    s_mul_i32 s10, s4, 17408
    v_add_u32 v12, s10, v12
    v_add_u32 v248, 67584, v12
    v_add_u32 v249, 129024, v12
    v_lshl_add_u32 v12, v7, 2, v9
    v_mul_u32_u24 v12, 1280, v12
    s_mul_i32 s10, s3, 320
    v_add_u32 v12, s10, v12
    v_lshl_add_u32 v13, v10, 3, v12
    v_lshl_add_u32 v12, v10, 4, v12
    s_mul_i32 s10, s3, 10240
    v_add_u32 v14, s10, v11
    v_mov_b32 v236, 0
    v_mov_b32 v237, 0
    v_mov_b32 v238, 0
    v_mov_b32 v239, 0
    s_nop 1
    v_mfma_f32_32x32x16_bf16 a[0:15], v[236:239], v[236:239], 0
    v_mfma_f32_32x32x16_bf16 a[16:31], v[236:239], v[236:239], 0
    v_mfma_f32_32x32x16_bf16 a[32:47], v[236:239], v[236:239], 0
    v_mfma_f32_32x32x16_bf16 a[48:63], v[236:239], v[236:239], 0
    v_mfma_f32_32x32x16_bf16 a[64:79], v[236:239], v[236:239], 0
    v_mfma_f32_32x32x16_bf16 a[80:95], v[236:239], v[236:239], 0
    v_mfma_f32_32x32x16_bf16 a[96:111], v[236:239], v[236:239], 0
    v_mfma_f32_32x32x16_bf16 a[112:127], v[236:239], v[236:239], 0
    v_mfma_f32_32x32x16_bf16 a[128:143], v[236:239], v[236:239], 0
    v_mfma_f32_32x32x16_bf16 a[144:159], v[236:239], v[236:239], 0
    v_mfma_f32_32x32x16_bf16 a[160:175], v[236:239], v[236:239], 0
    v_mfma_f32_32x32x16_bf16 a[176:191], v[236:239], v[236:239], 0
    v_mfma_f32_32x32x16_bf16 a[192:207], v[236:239], v[236:239], 0
    v_mfma_f32_32x32x16_bf16 a[208:223], v[236:239], v[236:239], 0
    s_waitcnt vmcnt(18)
    s_barrier
    ds_read_b128 v[160:163], v240 offset:0
    ds_read_b64_tr_b16 v[96:97], v248 offset:0
    ds_read_b64_tr_b16 v[98:99], v248 offset:4352
    ds_read_b64_tr_b16 v[100:101], v248 offset:8
    ds_read_b64_tr_b16 v[102:103], v248 offset:4360
    ds_read_b64_tr_b16 v[104:105], v248 offset:64
    ds_read_b64_tr_b16 v[106:107], v248 offset:4416
    ds_read_b64_tr_b16 v[108:109], v248 offset:72
    ds_read_b64_tr_b16 v[110:111], v248 offset:4424
    ds_read_b128 v[164:167], v240 offset:2048
    ds_read_b64_tr_b16 v[112:113], v248 offset:128
    ds_read_b64_tr_b16 v[114:115], v248 offset:4480
    ds_read_b64_tr_b16 v[116:117], v248 offset:136
    ds_read_b64_tr_b16 v[118:119], v248 offset:4488
    ds_read_b64_tr_b16 v[120:121], v248 offset:192
    ds_read_b64_tr_b16 v[122:123], v248 offset:4544
    ds_read_b64_tr_b16 v[124:125], v248 offset:200
    ds_read_b64_tr_b16 v[126:127], v248 offset:4552
    ds_read_b128 v[168:171], v240 offset:4096
    ds_read_b128 v[172:175], v240 offset:6144
    ds_read_b128 v[176:179], v240 offset:8192
    ds_read_b128 v[180:183], v240 offset:10240
    ds_read_b128 v[184:187], v244
    s_waitcnt lgkmcnt(4)
    v_mfma_f32_16x16x32_bf16 a[0:3], v[96:99], v[160:163], a[0:3]
    ds_read_b128 v[188:191], v241 offset:0
    v_mfma_f32_16x16x32_bf16 a[4:7], v[100:103], v[160:163], a[4:7]
    ds_read_b64_tr_b16 v[128:129], v248 offset:8704
    v_mfma_f32_16x16x32_bf16 a[8:11], v[104:107], v[160:163], a[8:11]
    ds_read_b64_tr_b16 v[130:131], v248 offset:13056
    v_mfma_f32_16x16x32_bf16 a[12:15], v[108:111], v[160:163], a[12:15]
    ds_read_b64_tr_b16 v[132:133], v248 offset:8712
    v_mfma_f32_16x16x32_bf16 a[16:19], v[112:115], v[160:163], a[16:19]
    v_mfma_f32_16x16x32_bf16 a[20:23], v[116:119], v[160:163], a[20:23]
    ds_read_b64_tr_b16 v[134:135], v248 offset:13064
    v_mfma_f32_16x16x32_bf16 a[24:27], v[120:123], v[160:163], a[24:27]
    ds_read_b64_tr_b16 v[136:137], v248 offset:8768
    v_mfma_f32_16x16x32_bf16 a[28:31], v[124:127], v[160:163], a[28:31]
    v_mfma_f32_16x16x32_bf16 a[32:35], v[96:99], v[164:167], a[32:35]
    ds_read_b64_tr_b16 v[138:139], v248 offset:13120
    v_mfma_f32_16x16x32_bf16 a[36:39], v[100:103], v[164:167], a[36:39]
    ds_read_b64_tr_b16 v[140:141], v248 offset:8776
    v_mfma_f32_16x16x32_bf16 a[40:43], v[104:107], v[164:167], a[40:43]
    v_mfma_f32_16x16x32_bf16 a[44:47], v[108:111], v[164:167], a[44:47]
    ds_read_b64_tr_b16 v[142:143], v248 offset:13128
    v_mfma_f32_16x16x32_bf16 a[48:51], v[112:115], v[164:167], a[48:51]
    v_mfma_f32_16x16x32_bf16 a[52:55], v[116:119], v[164:167], a[52:55]
    ds_read_b128 v[192:195], v241 offset:2048
    v_mfma_f32_16x16x32_bf16 a[56:59], v[120:123], v[164:167], a[56:59]
    ds_read_b64_tr_b16 v[144:145], v248 offset:8832
    v_mfma_f32_16x16x32_bf16 a[60:63], v[124:127], v[164:167], a[60:63]
    v_mfma_f32_16x16x32_bf16 a[64:67], v[96:99], v[168:171], a[64:67]
    ds_read_b64_tr_b16 v[146:147], v248 offset:13184
    v_mfma_f32_16x16x32_bf16 a[68:71], v[100:103], v[168:171], a[68:71]
    ds_read_b64_tr_b16 v[148:149], v248 offset:8840
    v_mfma_f32_16x16x32_bf16 a[72:75], v[104:107], v[168:171], a[72:75]
    v_mfma_f32_16x16x32_bf16 a[76:79], v[108:111], v[168:171], a[76:79]
    ds_read_b64_tr_b16 v[150:151], v248 offset:13192
    v_mfma_f32_16x16x32_bf16 a[80:83], v[112:115], v[168:171], a[80:83]
    ds_read_b64_tr_b16 v[152:153], v248 offset:8896
    v_mfma_f32_16x16x32_bf16 a[84:87], v[116:119], v[168:171], a[84:87]
    v_mfma_f32_16x16x32_bf16 a[88:91], v[120:123], v[168:171], a[88:91]
    ds_read_b64_tr_b16 v[154:155], v248 offset:13248
    v_mfma_f32_16x16x32_bf16 a[92:95], v[124:127], v[168:171], a[92:95]
    s_waitcnt lgkmcnt(15)
    v_mfma_f32_16x16x32_bf16 a[96:99], v[96:99], v[172:175], a[96:99]
    ds_read_b64_tr_b16 v[156:157], v248 offset:8904
    v_mfma_f32_16x16x32_bf16 a[100:103], v[100:103], v[172:175], a[100:103]
    ds_read_b64_tr_b16 v[158:159], v248 offset:13256
    v_mfma_f32_16x16x32_bf16 a[104:107], v[104:107], v[172:175], a[104:107]
    v_mfma_f32_16x16x32_bf16 a[108:111], v[108:111], v[172:175], a[108:111]
    ds_read_b128 v[196:199], v241 offset:4096
    v_mfma_f32_16x16x32_bf16 a[112:115], v[112:115], v[172:175], a[112:115]
    ds_read_b128 v[200:203], v241 offset:6144
    v_mfma_f32_16x16x32_bf16 a[116:119], v[116:119], v[172:175], a[116:119]
    v_mfma_f32_16x16x32_bf16 a[120:123], v[120:123], v[172:175], a[120:123]
    ds_read_b128 v[204:207], v241 offset:8192
    v_mfma_f32_16x16x32_bf16 a[124:127], v[124:127], v[172:175], a[124:127]
    ds_read_b128 v[208:211], v241 offset:10240
    v_mfma_f32_16x16x32_bf16 a[128:131], v[96:99], v[176:179], a[128:131]
    v_mfma_f32_16x16x32_bf16 a[132:135], v[100:103], v[176:179], a[132:135]
    ds_read_b128 v[212:215], v245
    v_mfma_f32_16x16x32_bf16 a[136:139], v[104:107], v[176:179], a[136:139]
    v_mfma_f32_16x16x32_bf16 a[140:143], v[108:111], v[176:179], a[140:143]
    v_mfma_f32_16x16x32_bf16 a[144:147], v[112:115], v[176:179], a[144:147]
    v_mfma_f32_16x16x32_bf16 a[148:151], v[116:119], v[176:179], a[148:151]
    v_mfma_f32_16x16x32_bf16 a[152:155], v[120:123], v[176:179], a[152:155]
    v_mfma_f32_16x16x32_bf16 a[156:159], v[124:127], v[176:179], a[156:159]
    v_mfma_f32_16x16x32_bf16 a[160:163], v[96:99], v[180:183], a[160:163]
    v_mfma_f32_16x16x32_bf16 a[164:167], v[100:103], v[180:183], a[164:167]
    v_mfma_f32_16x16x32_bf16 a[168:171], v[104:107], v[180:183], a[168:171]
    v_mfma_f32_16x16x32_bf16 a[172:175], v[108:111], v[180:183], a[172:175]
    v_mfma_f32_16x16x32_bf16 a[176:179], v[112:115], v[180:183], a[176:179]
    v_mfma_f32_16x16x32_bf16 a[180:183], v[116:119], v[180:183], a[180:183]
    v_mfma_f32_16x16x32_bf16 a[184:187], v[120:123], v[180:183], a[184:187]
    v_mfma_f32_16x16x32_bf16 a[188:191], v[124:127], v[180:183], a[188:191]
    s_cmp_eq_u32 s5, 0
    s_cbranch_scc0 L_q1_3
    v_mfma_f32_16x16x32_bf16 a[192:195], v[96:99], v[184:187], a[192:195]
    v_mfma_f32_16x16x32_bf16 a[196:199], v[100:103], v[184:187], a[196:199]
    v_mfma_f32_16x16x32_bf16 a[200:203], v[104:107], v[184:187], a[200:203]
    v_mfma_f32_16x16x32_bf16 a[204:207], v[108:111], v[184:187], a[204:207]
    s_branch L_q2_3
L_q1_3:
    v_mfma_f32_16x16x32_bf16 a[192:195], v[112:115], v[184:187], a[192:195]
    v_mfma_f32_16x16x32_bf16 a[196:199], v[116:119], v[184:187], a[196:199]
    v_mfma_f32_16x16x32_bf16 a[200:203], v[120:123], v[184:187], a[200:203]
    v_mfma_f32_16x16x32_bf16 a[204:207], v[124:127], v[184:187], a[204:207]
L_q2_3:
    s_waitcnt vmcnt(5) lgkmcnt(0)
    s_barrier
    v_mfma_f32_16x16x32_bf16 a[0:3], v[128:131], v[188:191], a[0:3]
    ds_read_b128 v[160:163], v242 offset:0
    v_mfma_f32_16x16x32_bf16 a[4:7], v[132:135], v[188:191], a[4:7]
    ds_read_b64_tr_b16 v[96:97], v249 offset:0
    v_mfma_f32_16x16x32_bf16 a[8:11], v[136:139], v[188:191], a[8:11]
    ds_read_b64_tr_b16 v[98:99], v249 offset:4352
    s_cmp_eq_u32 s3, 3
    s_cbranch_scc1 L_xs4
    s_add_u32 m0, s49, 46080
    s_add_u32 s52, s48, 51456
    buffer_load_dwordx4 v250, s[16:19], s52 offen  lds
    s_add_u32 m0, s49, 47104
    s_add_u32 s52, s48, 61696
    buffer_load_dwordx4 v250, s[16:19], s52 offen  lds
L_xs4:
    v_mfma_f32_16x16x32_bf16 a[12:15], v[140:143], v[188:191], a[12:15]
    ds_read_b64_tr_b16 v[100:101], v249 offset:8
    v_mfma_f32_16x16x32_bf16 a[16:19], v[144:147], v[188:191], a[16:19]
    v_mfma_f32_16x16x32_bf16 a[20:23], v[148:151], v[188:191], a[20:23]
    ds_read_b64_tr_b16 v[102:103], v249 offset:4360
    v_mfma_f32_16x16x32_bf16 a[24:27], v[152:155], v[188:191], a[24:27]
    ds_read_b64_tr_b16 v[104:105], v249 offset:64
    v_mfma_f32_16x16x32_bf16 a[28:31], v[156:159], v[188:191], a[28:31]
    s_add_u32 m0, s53, 67584
    s_add_u32 s52, s50, 1048576
    buffer_load_dwordx4 v15, s[20:23], s52 offen  lds
    v_mfma_f32_16x16x32_bf16 a[32:35], v[128:131], v[192:195], a[32:35]
    ds_read_b64_tr_b16 v[106:107], v249 offset:4416
    v_mfma_f32_16x16x32_bf16 a[36:39], v[132:135], v[192:195], a[36:39]
    ds_read_b64_tr_b16 v[108:109], v249 offset:72
    v_mfma_f32_16x16x32_bf16 a[40:43], v[136:139], v[192:195], a[40:43]
    s_add_u32 m0, s53, 68672
    s_add_u32 s52, s50, 1056768
    buffer_load_dwordx4 v15, s[20:23], s52 offen  lds
    v_mfma_f32_16x16x32_bf16 a[44:47], v[140:143], v[192:195], a[44:47]
    ds_read_b64_tr_b16 v[110:111], v249 offset:4424
    v_mfma_f32_16x16x32_bf16 a[48:51], v[144:147], v[192:195], a[48:51]
    v_mfma_f32_16x16x32_bf16 a[52:55], v[148:151], v[192:195], a[52:55]
    ds_read_b128 v[164:167], v242 offset:2048
    v_mfma_f32_16x16x32_bf16 a[56:59], v[152:155], v[192:195], a[56:59]
    ds_read_b64_tr_b16 v[112:113], v249 offset:128
    v_mfma_f32_16x16x32_bf16 a[60:63], v[156:159], v[192:195], a[60:63]
    s_add_u32 m0, s53, 69760
    s_add_u32 s52, s50, 1064960
    buffer_load_dwordx4 v15, s[20:23], s52 offen  lds
    v_mfma_f32_16x16x32_bf16 a[64:67], v[128:131], v[196:199], a[64:67]
    ds_read_b64_tr_b16 v[114:115], v249 offset:4480
    v_mfma_f32_16x16x32_bf16 a[68:71], v[132:135], v[196:199], a[68:71]
    ds_read_b64_tr_b16 v[116:117], v249 offset:136
    v_mfma_f32_16x16x32_bf16 a[72:75], v[136:139], v[196:199], a[72:75]
    v_mfma_f32_16x16x32_bf16 a[76:79], v[140:143], v[196:199], a[76:79]
    ds_read_b64_tr_b16 v[118:119], v249 offset:4488
    v_mfma_f32_16x16x32_bf16 a[80:83], v[144:147], v[196:199], a[80:83]
    ds_read_b64_tr_b16 v[120:121], v249 offset:192
    v_mfma_f32_16x16x32_bf16 a[84:87], v[148:151], v[196:199], a[84:87]
    s_add_u32 m0, s53, 70848
    s_add_u32 s52, s50, 1073152
    buffer_load_dwordx4 v15, s[20:23], s52 offen  lds
    v_mfma_f32_16x16x32_bf16 a[88:91], v[152:155], v[196:199], a[88:91]
    ds_read_b64_tr_b16 v[122:123], v249 offset:4544
    v_mfma_f32_16x16x32_bf16 a[92:95], v[156:159], v[196:199], a[92:95]
    s_add_u32 m0, s53, 71936
    s_add_u32 s52, s50, 1081344
    buffer_load_dwordx4 v15, s[20:23], s52 offen  lds
    v_mfma_f32_16x16x32_bf16 a[96:99], v[128:131], v[200:203], a[96:99]
    ds_read_b64_tr_b16 v[124:125], v249 offset:200
    v_mfma_f32_16x16x32_bf16 a[100:103], v[132:135], v[200:203], a[100:103]
    ds_read_b64_tr_b16 v[126:127], v249 offset:4552
    v_mfma_f32_16x16x32_bf16 a[104:107], v[136:139], v[200:203], a[104:107]
    v_mfma_f32_16x16x32_bf16 a[108:111], v[140:143], v[200:203], a[108:111]
    ds_read_b128 v[168:171], v242 offset:4096
    v_mfma_f32_16x16x32_bf16 a[112:115], v[144:147], v[200:203], a[112:115]
    ds_read_b128 v[172:175], v242 offset:6144
    v_mfma_f32_16x16x32_bf16 a[116:119], v[148:151], v[200:203], a[116:119]
    s_add_u32 m0, s53, 73024
    s_add_u32 s52, s50, 1089536
    buffer_load_dwordx4 v15, s[20:23], s52 offen  lds
    v_mfma_f32_16x16x32_bf16 a[120:123], v[152:155], v[200:203], a[120:123]
    ds_read_b128 v[176:179], v242 offset:8192
    v_mfma_f32_16x16x32_bf16 a[124:127], v[156:159], v[200:203], a[124:127]
    ds_read_b128 v[180:183], v242 offset:10240
    v_mfma_f32_16x16x32_bf16 a[128:131], v[128:131], v[204:207], a[128:131]
    s_add_u32 m0, s53, 74112
    s_add_u32 s52, s50, 1097728
    buffer_load_dwordx4 v15, s[20:23], s52 offen  lds
    v_mfma_f32_16x16x32_bf16 a[132:135], v[132:135], v[204:207], a[132:135]
    ds_read_b128 v[184:187], v246
    v_mfma_f32_16x16x32_bf16 a[136:139], v[136:139], v[204:207], a[136:139]
    v_mfma_f32_16x16x32_bf16 a[140:143], v[140:143], v[204:207], a[140:143]
    v_mfma_f32_16x16x32_bf16 a[144:147], v[144:147], v[204:207], a[144:147]
    v_mfma_f32_16x16x32_bf16 a[148:151], v[148:151], v[204:207], a[148:151]
    s_add_u32 m0, s53, 75200
    s_add_u32 s52, s50, 1105920
    buffer_load_dwordx4 v15, s[20:23], s52 offen  lds
    v_mfma_f32_16x16x32_bf16 a[152:155], v[152:155], v[204:207], a[152:155]
    v_mfma_f32_16x16x32_bf16 a[156:159], v[156:159], v[204:207], a[156:159]
    v_mfma_f32_16x16x32_bf16 a[160:163], v[128:131], v[208:211], a[160:163]
    v_mfma_f32_16x16x32_bf16 a[164:167], v[132:135], v[208:211], a[164:167]
    s_add_u32 m0, s49, 40960
    s_add_u32 s52, s48, 256
    buffer_load_dwordx4 v250, s[16:19], s52 offen  lds
    v_mfma_f32_16x16x32_bf16 a[168:171], v[136:139], v[208:211], a[168:171]
    v_mfma_f32_16x16x32_bf16 a[172:175], v[140:143], v[208:211], a[172:175]
    v_mfma_f32_16x16x32_bf16 a[176:179], v[144:147], v[208:211], a[176:179]
    v_mfma_f32_16x16x32_bf16 a[180:183], v[148:151], v[208:211], a[180:183]
    v_mfma_f32_16x16x32_bf16 a[184:187], v[152:155], v[208:211], a[184:187]
    v_mfma_f32_16x16x32_bf16 a[188:191], v[156:159], v[208:211], a[188:191]
    s_cmp_eq_u32 s5, 0
    s_cbranch_scc0 L_q1_5
    v_mfma_f32_16x16x32_bf16 a[192:195], v[128:131], v[212:215], a[192:195]
    v_mfma_f32_16x16x32_bf16 a[196:199], v[132:135], v[212:215], a[196:199]
    v_mfma_f32_16x16x32_bf16 a[200:203], v[136:139], v[212:215], a[200:203]
    v_mfma_f32_16x16x32_bf16 a[204:207], v[140:143], v[212:215], a[204:207]
    s_branch L_q2_5
L_q1_5:
    v_mfma_f32_16x16x32_bf16 a[192:195], v[144:147], v[212:215], a[192:195]
    v_mfma_f32_16x16x32_bf16 a[196:199], v[148:151], v[212:215], a[196:199]
    v_mfma_f32_16x16x32_bf16 a[200:203], v[152:155], v[212:215], a[200:203]
    v_mfma_f32_16x16x32_bf16 a[204:207], v[156:159], v[212:215], a[204:207]
L_q2_5:
    s_waitcnt lgkmcnt(5)
    v_mfma_f32_16x16x32_bf16 a[0:3], v[96:99], v[160:163], a[0:3]
    ds_read_b128 v[188:191], v243 offset:0
    v_mfma_f32_16x16x32_bf16 a[4:7], v[100:103], v[160:163], a[4:7]
    ds_read_b64_tr_b16 v[128:129], v249 offset:8704
    s_add_u32 m0, s49, 41984
    s_add_u32 s52, s48, 10496
    buffer_load_dwordx4 v250, s[16:19], s52 offen  lds
    v_mfma_f32_16x16x32_bf16 a[8:11], v[104:107], v[160:163], a[8:11]
    ds_read_b64_tr_b16 v[130:131], v249 offset:13056
    v_mfma_f32_16x16x32_bf16 a[12:15], v[108:111], v[160:163], a[12:15]
    ds_read_b64_tr_b16 v[132:133], v249 offset:8712
    v_mfma_f32_16x16x32_bf16 a[16:19], v[112:115], v[160:163], a[16:19]
    v_mfma_f32_16x16x32_bf16 a[20:23], v[116:119], v[160:163], a[20:23]
    ds_read_b64_tr_b16 v[134:135], v249 offset:13064
    v_mfma_f32_16x16x32_bf16 a[24:27], v[120:123], v[160:163], a[24:27]
    ds_read_b64_tr_b16 v[136:137], v249 offset:8768
    v_mfma_f32_16x16x32_bf16 a[28:31], v[124:127], v[160:163], a[28:31]
    s_add_u32 m0, s49, 43008
    s_add_u32 s52, s48, 20736
    buffer_load_dwordx4 v250, s[16:19], s52 offen  lds
    v_mfma_f32_16x16x32_bf16 a[32:35], v[96:99], v[164:167], a[32:35]
    ds_read_b64_tr_b16 v[138:139], v249 offset:13120
    v_mfma_f32_16x16x32_bf16 a[36:39], v[100:103], v[164:167], a[36:39]
    ds_read_b64_tr_b16 v[140:141], v249 offset:8776
    v_mfma_f32_16x16x32_bf16 a[40:43], v[104:107], v[164:167], a[40:43]
    v_mfma_f32_16x16x32_bf16 a[44:47], v[108:111], v[164:167], a[44:47]
    ds_read_b64_tr_b16 v[142:143], v249 offset:13128
    v_mfma_f32_16x16x32_bf16 a[48:51], v[112:115], v[164:167], a[48:51]
    s_add_u32 m0, s49, 44032
    s_add_u32 s52, s48, 30976
    buffer_load_dwordx4 v250, s[16:19], s52 offen  lds
    v_mfma_f32_16x16x32_bf16 a[52:55], v[116:119], v[164:167], a[52:55]
    ds_read_b128 v[192:195], v243 offset:2048
    v_mfma_f32_16x16x32_bf16 a[56:59], v[120:123], v[164:167], a[56:59]
    ds_read_b64_tr_b16 v[144:145], v249 offset:8832
    v_mfma_f32_16x16x32_bf16 a[60:63], v[124:127], v[164:167], a[60:63]
    s_waitcnt lgkmcnt(14)
    v_mfma_f32_16x16x32_bf16 a[64:67], v[96:99], v[168:171], a[64:67]
    ds_read_b64_tr_b16 v[146:147], v249 offset:13184
    v_mfma_f32_16x16x32_bf16 a[68:71], v[100:103], v[168:171], a[68:71]
    ds_read_b64_tr_b16 v[148:149], v249 offset:8840
    v_mfma_f32_16x16x32_bf16 a[72:75], v[104:107], v[168:171], a[72:75]
    s_add_u32 m0, s49, 45056
    s_add_u32 s52, s48, 41216
    buffer_load_dwordx4 v250, s[16:19], s52 offen  lds
    v_mfma_f32_16x16x32_bf16 a[76:79], v[108:111], v[168:171], a[76:79]
    ds_read_b64_tr_b16 v[150:151], v249 offset:13192
    v_mfma_f32_16x16x32_bf16 a[80:83], v[112:115], v[168:171], a[80:83]
    ds_read_b64_tr_b16 v[152:153], v249 offset:8896
    v_mfma_f32_16x16x32_bf16 a[84:87], v[116:119], v[168:171], a[84:87]
    v_mfma_f32_16x16x32_bf16 a[88:91], v[120:123], v[168:171], a[88:91]
    ds_read_b64_tr_b16 v[154:155], v249 offset:13248
    v_mfma_f32_16x16x32_bf16 a[92:95], v[124:127], v[168:171], a[92:95]
    v_mfma_f32_16x16x32_bf16 a[96:99], v[96:99], v[172:175], a[96:99]
    ds_read_b64_tr_b16 v[156:157], v249 offset:8904
    s_add_u32 m0, s54, 0
    s_add_u32 s11, s54, 0
    buffer_load_dwordx4 v11, s[28:31], s11 offen nt lds
    v_mfma_f32_16x16x32_bf16 a[100:103], v[100:103], v[172:175], a[100:103]
    ds_read_b64_tr_b16 v[158:159], v249 offset:13256
    v_mfma_f32_16x16x32_bf16 a[104:107], v[104:107], v[172:175], a[104:107]
    s_add_u32 m0, s54, 1024
    s_add_u32 s11, s54, 1024
    buffer_load_dwordx4 v11, s[28:31], s11 offen nt lds
    v_mfma_f32_16x16x32_bf16 a[108:111], v[108:111], v[172:175], a[108:111]
    ds_read_b128 v[196:199], v243 offset:4096
    v_mfma_f32_16x16x32_bf16 a[112:115], v[112:115], v[172:175], a[112:115]
    ds_read_b128 v[200:203], v243 offset:6144
    v_mfma_f32_16x16x32_bf16 a[116:119], v[116:119], v[172:175], a[116:119]
    s_add_u32 m0, s54, 2048
    s_add_u32 s11, s54, 2048
    buffer_load_dwordx4 v11, s[28:31], s11 offen nt lds
    v_mfma_f32_16x16x32_bf16 a[120:123], v[120:123], v[172:175], a[120:123]
    ds_read_b128 v[204:207], v243 offset:8192
    s_add_u32 m0, s54, 3072
    s_add_u32 s11, s54, 3072
    buffer_load_dwordx4 v11, s[28:31], s11 offen nt lds
    v_mfma_f32_16x16x32_bf16 a[124:127], v[124:127], v[172:175], a[124:127]
    ds_read_b128 v[208:211], v243 offset:10240
    s_waitcnt lgkmcnt(15)
    v_mfma_f32_16x16x32_bf16 a[128:131], v[96:99], v[176:179], a[128:131]
    s_add_u32 m0, s54, 4096
    s_add_u32 s11, s54, 4096
    buffer_load_dwordx4 v11, s[28:31], s11 offen nt lds
    v_mfma_f32_16x16x32_bf16 a[132:135], v[100:103], v[176:179], a[132:135]
    ds_read_b128 v[212:215], v247
    v_mfma_f32_16x16x32_bf16 a[136:139], v[104:107], v[176:179], a[136:139]
    s_add_u32 m0, s54, 5120
    s_add_u32 s11, s54, 5120
    buffer_load_dwordx4 v11, s[28:31], s11 offen nt lds
    v_mfma_f32_16x16x32_bf16 a[140:143], v[108:111], v[176:179], a[140:143]
    v_mfma_f32_16x16x32_bf16 a[144:147], v[112:115], v[176:179], a[144:147]
    s_add_u32 m0, s54, 6144
    s_add_u32 s11, s54, 6144
    buffer_load_dwordx4 v11, s[28:31], s11 offen nt lds
    v_mfma_f32_16x16x32_bf16 a[148:151], v[116:119], v[176:179], a[148:151]
    v_mfma_f32_16x16x32_bf16 a[152:155], v[120:123], v[176:179], a[152:155]
    v_mfma_f32_16x16x32_bf16 a[156:159], v[124:127], v[176:179], a[156:159]
    s_add_u32 m0, s54, 7168
    s_add_u32 s11, s54, 7168
    buffer_load_dwordx4 v11, s[28:31], s11 offen nt lds
    v_mfma_f32_16x16x32_bf16 a[160:163], v[96:99], v[180:183], a[160:163]
    v_mfma_f32_16x16x32_bf16 a[164:167], v[100:103], v[180:183], a[164:167]
    s_add_u32 m0, s54, 8192
    s_add_u32 s11, s54, 8192
    buffer_load_dwordx4 v11, s[28:31], s11 offen nt lds
    v_mfma_f32_16x16x32_bf16 a[168:171], v[104:107], v[180:183], a[168:171]
    v_mfma_f32_16x16x32_bf16 a[172:175], v[108:111], v[180:183], a[172:175]
    s_add_u32 m0, s54, 9216
    s_add_u32 s11, s54, 9216
    buffer_load_dwordx4 v11, s[28:31], s11 offen nt lds
    v_mfma_f32_16x16x32_bf16 a[176:179], v[112:115], v[180:183], a[176:179]
    v_mfma_f32_16x16x32_bf16 a[180:183], v[116:119], v[180:183], a[180:183]
    v_mfma_f32_16x16x32_bf16 a[184:187], v[120:123], v[180:183], a[184:187]
    v_mfma_f32_16x16x32_bf16 a[188:191], v[124:127], v[180:183], a[188:191]
    s_cmp_eq_u32 s5, 0
    s_cbranch_scc0 L_q1_6
    v_mfma_f32_16x16x32_bf16 a[192:195], v[96:99], v[184:187], a[192:195]
    v_mfma_f32_16x16x32_bf16 a[196:199], v[100:103], v[184:187], a[196:199]
    v_mfma_f32_16x16x32_bf16 a[200:203], v[104:107], v[184:187], a[200:203]
    v_mfma_f32_16x16x32_bf16 a[204:207], v[108:111], v[184:187], a[204:207]
    s_branch L_q2_6
L_q1_6:
    v_mfma_f32_16x16x32_bf16 a[192:195], v[112:115], v[184:187], a[192:195]
    v_mfma_f32_16x16x32_bf16 a[196:199], v[116:119], v[184:187], a[196:199]
    v_mfma_f32_16x16x32_bf16 a[200:203], v[120:123], v[184:187], a[200:203]
    v_mfma_f32_16x16x32_bf16 a[204:207], v[124:127], v[184:187], a[204:207]
L_q2_6:
    s_waitcnt vmcnt(10) lgkmcnt(0)
    s_barrier
    v_mfma_f32_16x16x32_bf16 a[0:3], v[128:131], v[188:191], a[0:3]
    ds_read_b128 v[160:163], v240 offset:0
    v_mfma_f32_16x16x32_bf16 a[4:7], v[132:135], v[188:191], a[4:7]
    ds_read_b64_tr_b16 v[96:97], v248 offset:0
    v_mfma_f32_16x16x32_bf16 a[8:11], v[136:139], v[188:191], a[8:11]
    ds_read_b64_tr_b16 v[98:99], v248 offset:4352
    s_cmp_eq_u32 s3, 3
    s_cbranch_scc1 L_xs7
    s_add_u32 m0, s49, 107520
    s_add_u32 s52, s48, 51584
    buffer_load_dwordx4 v250, s[16:19], s52 offen  lds
    s_add_u32 m0, s49, 108544
    s_add_u32 s52, s48, 61824
    buffer_load_dwordx4 v250, s[16:19], s52 offen  lds
L_xs7:
    v_mfma_f32_16x16x32_bf16 a[12:15], v[140:143], v[188:191], a[12:15]
    ds_read_b64_tr_b16 v[100:101], v248 offset:8
    v_mfma_f32_16x16x32_bf16 a[16:19], v[144:147], v[188:191], a[16:19]
    v_mfma_f32_16x16x32_bf16 a[20:23], v[148:151], v[188:191], a[20:23]
    ds_read_b64_tr_b16 v[102:103], v248 offset:4360
    v_mfma_f32_16x16x32_bf16 a[24:27], v[152:155], v[188:191], a[24:27]
    ds_read_b64_tr_b16 v[104:105], v248 offset:64
    v_mfma_f32_16x16x32_bf16 a[28:31], v[156:159], v[188:191], a[28:31]
    s_add_u32 m0, s53, 129024
    s_add_u32 s52, s50, 1572864
    buffer_load_dwordx4 v15, s[20:23], s52 offen  lds
    v_mfma_f32_16x16x32_bf16 a[32:35], v[128:131], v[192:195], a[32:35]
    ds_read_b64_tr_b16 v[106:107], v248 offset:4416
    v_mfma_f32_16x16x32_bf16 a[36:39], v[132:135], v[192:195], a[36:39]
    ds_read_b64_tr_b16 v[108:109], v248 offset:72
    v_mfma_f32_16x16x32_bf16 a[40:43], v[136:139], v[192:195], a[40:43]
    s_add_u32 m0, s53, 130112
    s_add_u32 s52, s50, 1581056
    buffer_load_dwordx4 v15, s[20:23], s52 offen  lds
    v_mfma_f32_16x16x32_bf16 a[44:47], v[140:143], v[192:195], a[44:47]
    ds_read_b64_tr_b16 v[110:111], v248 offset:4424
    v_mfma_f32_16x16x32_bf16 a[48:51], v[144:147], v[192:195], a[48:51]
    v_mfma_f32_16x16x32_bf16 a[52:55], v[148:151], v[192:195], a[52:55]
    ds_read_b128 v[164:167], v240 offset:2048
    v_mfma_f32_16x16x32_bf16 a[56:59], v[152:155], v[192:195], a[56:59]
    ds_read_b64_tr_b16 v[112:113], v248 offset:128
    v_mfma_f32_16x16x32_bf16 a[60:63], v[156:159], v[192:195], a[60:63]
    s_add_u32 m0, s53, 131200
    s_add_u32 s52, s50, 1589248
    buffer_load_dwordx4 v15, s[20:23], s52 offen  lds
    v_mfma_f32_16x16x32_bf16 a[64:67], v[128:131], v[196:199], a[64:67]
    ds_read_b64_tr_b16 v[114:115], v248 offset:4480
    v_mfma_f32_16x16x32_bf16 a[68:71], v[132:135], v[196:199], a[68:71]
    ds_read_b64_tr_b16 v[116:117], v248 offset:136
    v_mfma_f32_16x16x32_bf16 a[72:75], v[136:139], v[196:199], a[72:75]
    v_mfma_f32_16x16x32_bf16 a[76:79], v[140:143], v[196:199], a[76:79]
    ds_read_b64_tr_b16 v[118:119], v248 offset:4488
    v_mfma_f32_16x16x32_bf16 a[80:83], v[144:147], v[196:199], a[80:83]
    ds_read_b64_tr_b16 v[120:121], v248 offset:192
    v_mfma_f32_16x16x32_bf16 a[84:87], v[148:151], v[196:199], a[84:87]
    s_add_u32 m0, s53, 132288
    s_add_u32 s52, s50, 1597440
    buffer_load_dwordx4 v15, s[20:23], s52 offen  lds
    v_mfma_f32_16x16x32_bf16 a[88:91], v[152:155], v[196:199], a[88:91]
    ds_read_b64_tr_b16 v[122:123], v248 offset:4544
    v_mfma_f32_16x16x32_bf16 a[92:95], v[156:159], v[196:199], a[92:95]
    s_add_u32 m0, s53, 133376
    s_add_u32 s52, s50, 1605632
    buffer_load_dwordx4 v15, s[20:23], s52 offen  lds
    v_mfma_f32_16x16x32_bf16 a[96:99], v[128:131], v[200:203], a[96:99]
    ds_read_b64_tr_b16 v[124:125], v248 offset:200
    v_mfma_f32_16x16x32_bf16 a[100:103], v[132:135], v[200:203], a[100:103]
    ds_read_b64_tr_b16 v[126:127], v248 offset:4552
    v_mfma_f32_16x16x32_bf16 a[104:107], v[136:139], v[200:203], a[104:107]
    v_mfma_f32_16x16x32_bf16 a[108:111], v[140:143], v[200:203], a[108:111]
    ds_read_b128 v[168:171], v240 offset:4096
    v_mfma_f32_16x16x32_bf16 a[112:115], v[144:147], v[200:203], a[112:115]
    ds_read_b128 v[172:175], v240 offset:6144
    v_mfma_f32_16x16x32_bf16 a[116:119], v[148:151], v[200:203], a[116:119]
    s_add_u32 m0, s53, 134464
    s_add_u32 s52, s50, 1613824
    buffer_load_dwordx4 v15, s[20:23], s52 offen  lds
    v_mfma_f32_16x16x32_bf16 a[120:123], v[152:155], v[200:203], a[120:123]
    ds_read_b128 v[176:179], v240 offset:8192
    v_mfma_f32_16x16x32_bf16 a[124:127], v[156:159], v[200:203], a[124:127]
    ds_read_b128 v[180:183], v240 offset:10240
    v_mfma_f32_16x16x32_bf16 a[128:131], v[128:131], v[204:207], a[128:131]
    s_add_u32 m0, s53, 135552
    s_add_u32 s52, s50, 1622016
    buffer_load_dwordx4 v15, s[20:23], s52 offen  lds
    v_mfma_f32_16x16x32_bf16 a[132:135], v[132:135], v[204:207], a[132:135]
    ds_read_b128 v[184:187], v244
    v_mfma_f32_16x16x32_bf16 a[136:139], v[136:139], v[204:207], a[136:139]
    v_mfma_f32_16x16x32_bf16 a[140:143], v[140:143], v[204:207], a[140:143]
    v_mfma_f32_16x16x32_bf16 a[144:147], v[144:147], v[204:207], a[144:147]
    v_mfma_f32_16x16x32_bf16 a[148:151], v[148:151], v[204:207], a[148:151]
    s_add_u32 m0, s53, 136640
    s_add_u32 s52, s50, 1630208
    buffer_load_dwordx4 v15, s[20:23], s52 offen  lds
    v_mfma_f32_16x16x32_bf16 a[152:155], v[152:155], v[204:207], a[152:155]
    v_mfma_f32_16x16x32_bf16 a[156:159], v[156:159], v[204:207], a[156:159]
    v_mfma_f32_16x16x32_bf16 a[160:163], v[128:131], v[208:211], a[160:163]
    v_mfma_f32_16x16x32_bf16 a[164:167], v[132:135], v[208:211], a[164:167]
    s_add_u32 m0, s49, 102400
    s_add_u32 s52, s48, 384
    buffer_load_dwordx4 v250, s[16:19], s52 offen  lds
    v_mfma_f32_16x16x32_bf16 a[168:171], v[136:139], v[208:211], a[168:171]
    v_mfma_f32_16x16x32_bf16 a[172:175], v[140:143], v[208:211], a[172:175]
    v_mfma_f32_16x16x32_bf16 a[176:179], v[144:147], v[208:211], a[176:179]
    v_mfma_f32_16x16x32_bf16 a[180:183], v[148:151], v[208:211], a[180:183]
    v_mfma_f32_16x16x32_bf16 a[184:187], v[152:155], v[208:211], a[184:187]
    v_mfma_f32_16x16x32_bf16 a[188:191], v[156:159], v[208:211], a[188:191]
    s_cmp_eq_u32 s5, 0
    s_cbranch_scc0 L_q1_8
    v_mfma_f32_16x16x32_bf16 a[192:195], v[128:131], v[212:215], a[192:195]
    v_mfma_f32_16x16x32_bf16 a[196:199], v[132:135], v[212:215], a[196:199]
    v_mfma_f32_16x16x32_bf16 a[200:203], v[136:139], v[212:215], a[200:203]
    v_mfma_f32_16x16x32_bf16 a[204:207], v[140:143], v[212:215], a[204:207]
    s_branch L_q2_8
L_q1_8:
    v_mfma_f32_16x16x32_bf16 a[192:195], v[144:147], v[212:215], a[192:195]
    v_mfma_f32_16x16x32_bf16 a[196:199], v[148:151], v[212:215], a[196:199]
    v_mfma_f32_16x16x32_bf16 a[200:203], v[152:155], v[212:215], a[200:203]
    v_mfma_f32_16x16x32_bf16 a[204:207], v[156:159], v[212:215], a[204:207]
L_q2_8:
    s_waitcnt lgkmcnt(5)
    v_mfma_f32_16x16x32_bf16 a[0:3], v[96:99], v[160:163], a[0:3]
    ds_read_b128 v[188:191], v241 offset:0
    v_mfma_f32_16x16x32_bf16 a[4:7], v[100:103], v[160:163], a[4:7]
    ds_read_b64_tr_b16 v[128:129], v248 offset:8704
    s_add_u32 m0, s49, 103424
    s_add_u32 s52, s48, 10624
    buffer_load_dwordx4 v250, s[16:19], s52 offen  lds
    v_mfma_f32_16x16x32_bf16 a[8:11], v[104:107], v[160:163], a[8:11]
    ds_read_b64_tr_b16 v[130:131], v248 offset:13056
    v_mfma_f32_16x16x32_bf16 a[12:15], v[108:111], v[160:163], a[12:15]
    ds_read_b64_tr_b16 v[132:133], v248 offset:8712
    v_mfma_f32_16x16x32_bf16 a[16:19], v[112:115], v[160:163], a[16:19]
    v_mfma_f32_16x16x32_bf16 a[20:23], v[116:119], v[160:163], a[20:23]
    ds_read_b64_tr_b16 v[134:135], v248 offset:13064
    v_mfma_f32_16x16x32_bf16 a[24:27], v[120:123], v[160:163], a[24:27]
    ds_read_b64_tr_b16 v[136:137], v248 offset:8768
    v_mfma_f32_16x16x32_bf16 a[28:31], v[124:127], v[160:163], a[28:31]
    s_add_u32 m0, s49, 104448
    s_add_u32 s52, s48, 20864
    buffer_load_dwordx4 v250, s[16:19], s52 offen  lds
    v_mfma_f32_16x16x32_bf16 a[32:35], v[96:99], v[164:167], a[32:35]
    ds_read_b64_tr_b16 v[138:139], v248 offset:13120
    v_mfma_f32_16x16x32_bf16 a[36:39], v[100:103], v[164:167], a[36:39]
    ds_read_b64_tr_b16 v[140:141], v248 offset:8776
    v_mfma_f32_16x16x32_bf16 a[40:43], v[104:107], v[164:167], a[40:43]
    v_mfma_f32_16x16x32_bf16 a[44:47], v[108:111], v[164:167], a[44:47]
    ds_read_b64_tr_b16 v[142:143], v248 offset:13128
    v_mfma_f32_16x16x32_bf16 a[48:51], v[112:115], v[164:167], a[48:51]
    s_add_u32 m0, s49, 105472
    s_add_u32 s52, s48, 31104
    buffer_load_dwordx4 v250, s[16:19], s52 offen  lds
    v_mfma_f32_16x16x32_bf16 a[52:55], v[116:119], v[164:167], a[52:55]
    ds_read_b128 v[192:195], v241 offset:2048
    v_mfma_f32_16x16x32_bf16 a[56:59], v[120:123], v[164:167], a[56:59]
    ds_read_b64_tr_b16 v[144:145], v248 offset:8832
    v_mfma_f32_16x16x32_bf16 a[60:63], v[124:127], v[164:167], a[60:63]
    s_waitcnt lgkmcnt(14)
    v_mfma_f32_16x16x32_bf16 a[64:67], v[96:99], v[168:171], a[64:67]
    ds_read_b64_tr_b16 v[146:147], v248 offset:13184
    v_mfma_f32_16x16x32_bf16 a[68:71], v[100:103], v[168:171], a[68:71]
    ds_read_b64_tr_b16 v[148:149], v248 offset:8840
    v_mfma_f32_16x16x32_bf16 a[72:75], v[104:107], v[168:171], a[72:75]
    s_add_u32 m0, s49, 106496
    s_add_u32 s52, s48, 41344
    buffer_load_dwordx4 v250, s[16:19], s52 offen  lds
    v_mfma_f32_16x16x32_bf16 a[76:79], v[108:111], v[168:171], a[76:79]
    ds_read_b64_tr_b16 v[150:151], v248 offset:13192
    v_mfma_f32_16x16x32_bf16 a[80:83], v[112:115], v[168:171], a[80:83]
    ds_read_b64_tr_b16 v[152:153], v248 offset:8896
    v_mfma_f32_16x16x32_bf16 a[84:87], v[116:119], v[168:171], a[84:87]
    v_mfma_f32_16x16x32_bf16 a[88:91], v[120:123], v[168:171], a[88:91]
    ds_read_b64_tr_b16 v[154:155], v248 offset:13248
    v_mfma_f32_16x16x32_bf16 a[92:95], v[124:127], v[168:171], a[92:95]
    v_mfma_f32_16x16x32_bf16 a[96:99], v[96:99], v[172:175], a[96:99]
    ds_read_b64_tr_b16 v[156:157], v248 offset:8904
    v_mfma_f32_16x16x32_bf16 a[100:103], v[100:103], v[172:175], a[100:103]
    ds_read_b64_tr_b16 v[158:159], v248 offset:13256
    v_mfma_f32_16x16x32_bf16 a[104:107], v[104:107], v[172:175], a[104:107]
    v_mfma_f32_16x16x32_bf16 a[108:111], v[108:111], v[172:175], a[108:111]
    ds_read_b128 v[196:199], v241 offset:4096
    v_mfma_f32_16x16x32_bf16 a[112:115], v[112:115], v[172:175], a[112:115]
    ds_read_b128 v[200:203], v241 offset:6144
    v_mfma_f32_16x16x32_bf16 a[116:119], v[116:119], v[172:175], a[116:119]
    v_mfma_f32_16x16x32_bf16 a[120:123], v[120:123], v[172:175], a[120:123]
    ds_read_b128 v[204:207], v241 offset:8192
    v_mfma_f32_16x16x32_bf16 a[124:127], v[124:127], v[172:175], a[124:127]
    ds_read_b128 v[208:211], v241 offset:10240
    s_waitcnt lgkmcnt(15)
    v_mfma_f32_16x16x32_bf16 a[128:131], v[96:99], v[176:179], a[128:131]
    v_mfma_f32_16x16x32_bf16 a[132:135], v[100:103], v[176:179], a[132:135]
    ds_read_b128 v[212:215], v245
    v_mfma_f32_16x16x32_bf16 a[136:139], v[104:107], v[176:179], a[136:139]
    v_mfma_f32_16x16x32_bf16 a[140:143], v[108:111], v[176:179], a[140:143]
    v_mfma_f32_16x16x32_bf16 a[144:147], v[112:115], v[176:179], a[144:147]
    v_mfma_f32_16x16x32_bf16 a[148:151], v[116:119], v[176:179], a[148:151]
    v_mfma_f32_16x16x32_bf16 a[152:155], v[120:123], v[176:179], a[152:155]
    v_mfma_f32_16x16x32_bf16 a[156:159], v[124:127], v[176:179], a[156:159]
    v_mfma_f32_16x16x32_bf16 a[160:163], v[96:99], v[180:183], a[160:163]
    v_mfma_f32_16x16x32_bf16 a[164:167], v[100:103], v[180:183], a[164:167]
    v_mfma_f32_16x16x32_bf16 a[168:171], v[104:107], v[180:183], a[168:171]
    v_mfma_f32_16x16x32_bf16 a[172:175], v[108:111], v[180:183], a[172:175]
    v_mfma_f32_16x16x32_bf16 a[176:179], v[112:115], v[180:183], a[176:179]
    v_mfma_f32_16x16x32_bf16 a[180:183], v[116:119], v[180:183], a[180:183]
    v_mfma_f32_16x16x32_bf16 a[184:187], v[120:123], v[180:183], a[184:187]
    v_mfma_f32_16x16x32_bf16 a[188:191], v[124:127], v[180:183], a[188:191]
    s_cmp_eq_u32 s5, 0
    s_cbranch_scc0 L_q1_9
    v_mfma_f32_16x16x32_bf16 a[192:195], v[96:99], v[184:187], a[192:195]
    v_mfma_f32_16x16x32_bf16 a[196:199], v[100:103], v[184:187], a[196:199]
    v_mfma_f32_16x16x32_bf16 a[200:203], v[104:107], v[184:187], a[200:203]
    v_mfma_f32_16x16x32_bf16 a[204:207], v[108:111], v[184:187], a[204:207]
    s_branch L_q2_9
L_q1_9:
    v_mfma_f32_16x16x32_bf16 a[192:195], v[112:115], v[184:187], a[192:195]
    v_mfma_f32_16x16x32_bf16 a[196:199], v[116:119], v[184:187], a[196:199]
    v_mfma_f32_16x16x32_bf16 a[200:203], v[120:123], v[184:187], a[200:203]
    v_mfma_f32_16x16x32_bf16 a[204:207], v[124:127], v[184:187], a[204:207]
L_q2_9:
    s_waitcnt vmcnt(0) lgkmcnt(0)
    s_barrier
    v_mfma_f32_16x16x32_bf16 a[0:3], v[128:131], v[188:191], a[0:3]
    ds_read_b128 v[160:163], v242 offset:0
    v_mfma_f32_16x16x32_bf16 a[4:7], v[132:135], v[188:191], a[4:7]
    ds_read_b64_tr_b16 v[96:97], v249 offset:0
    v_mfma_f32_16x16x32_bf16 a[8:11], v[136:139], v[188:191], a[8:11]
    ds_read_b64_tr_b16 v[98:99], v249 offset:4352
    s_cmp_eq_u32 s3, 3
    s_cbranch_scc1 L_xs10
    s_add_u32 m0, s49, 46080
    s_add_u32 s52, s48, 51712
    buffer_load_dwordx4 v250, s[16:19], s52 offen  lds
    s_add_u32 m0, s49, 47104
    s_add_u32 s52, s48, 61952
    buffer_load_dwordx4 v250, s[16:19], s52 offen  lds
L_xs10:
    v_mfma_f32_16x16x32_bf16 a[12:15], v[140:143], v[188:191], a[12:15]
    ds_read_b64_tr_b16 v[100:101], v249 offset:8
    v_mfma_f32_16x16x32_bf16 a[16:19], v[144:147], v[188:191], a[16:19]
    v_mfma_f32_16x16x32_bf16 a[20:23], v[148:151], v[188:191], a[20:23]
    ds_read_b64_tr_b16 v[102:103], v249 offset:4360
    v_mfma_f32_16x16x32_bf16 a[24:27], v[152:155], v[188:191], a[24:27]
    ds_read_b64_tr_b16 v[104:105], v249 offset:64
    v_mfma_f32_16x16x32_bf16 a[28:31], v[156:159], v[188:191], a[28:31]
    s_add_u32 m0, s53, 67584
    s_add_u32 s52, s50, 2097152
    buffer_load_dwordx4 v15, s[20:23], s52 offen  lds
    v_mfma_f32_16x16x32_bf16 a[32:35], v[128:131], v[192:195], a[32:35]
    ds_read_b64_tr_b16 v[106:107], v249 offset:4416
    v_mfma_f32_16x16x32_bf16 a[36:39], v[132:135], v[192:195], a[36:39]
    ds_read_b64_tr_b16 v[108:109], v249 offset:72
    v_mfma_f32_16x16x32_bf16 a[40:43], v[136:139], v[192:195], a[40:43]
    s_add_u32 m0, s53, 68672
    s_add_u32 s52, s50, 2105344
    buffer_load_dwordx4 v15, s[20:23], s52 offen  lds
    v_mfma_f32_16x16x32_bf16 a[44:47], v[140:143], v[192:195], a[44:47]
    ds_read_b64_tr_b16 v[110:111], v249 offset:4424
    v_mfma_f32_16x16x32_bf16 a[48:51], v[144:147], v[192:195], a[48:51]
    v_mfma_f32_16x16x32_bf16 a[52:55], v[148:151], v[192:195], a[52:55]
    ds_read_b128 v[164:167], v242 offset:2048
    v_mfma_f32_16x16x32_bf16 a[56:59], v[152:155], v[192:195], a[56:59]
    ds_read_b64_tr_b16 v[112:113], v249 offset:128
    v_mfma_f32_16x16x32_bf16 a[60:63], v[156:159], v[192:195], a[60:63]
    s_add_u32 m0, s53, 69760
    s_add_u32 s52, s50, 2113536
    buffer_load_dwordx4 v15, s[20:23], s52 offen  lds
    v_mfma_f32_16x16x32_bf16 a[64:67], v[128:131], v[196:199], a[64:67]
    ds_read_b64_tr_b16 v[114:115], v249 offset:4480
    v_mfma_f32_16x16x32_bf16 a[68:71], v[132:135], v[196:199], a[68:71]
    ds_read_b64_tr_b16 v[116:117], v249 offset:136
    v_mfma_f32_16x16x32_bf16 a[72:75], v[136:139], v[196:199], a[72:75]
    v_mfma_f32_16x16x32_bf16 a[76:79], v[140:143], v[196:199], a[76:79]
    ds_read_b64_tr_b16 v[118:119], v249 offset:4488
    v_mfma_f32_16x16x32_bf16 a[80:83], v[144:147], v[196:199], a[80:83]
    ds_read_b64_tr_b16 v[120:121], v249 offset:192
    v_mfma_f32_16x16x32_bf16 a[84:87], v[148:151], v[196:199], a[84:87]
    s_add_u32 m0, s53, 70848
    s_add_u32 s52, s50, 2121728
    buffer_load_dwordx4 v15, s[20:23], s52 offen  lds
    v_mfma_f32_16x16x32_bf16 a[88:91], v[152:155], v[196:199], a[88:91]
    ds_read_b64_tr_b16 v[122:123], v249 offset:4544
    v_mfma_f32_16x16x32_bf16 a[92:95], v[156:159], v[196:199], a[92:95]
    s_add_u32 m0, s53, 71936
    s_add_u32 s52, s50, 2129920
    buffer_load_dwordx4 v15, s[20:23], s52 offen  lds
    v_mfma_f32_16x16x32_bf16 a[96:99], v[128:131], v[200:203], a[96:99]
    ds_read_b64_tr_b16 v[124:125], v249 offset:200
    v_mfma_f32_16x16x32_bf16 a[100:103], v[132:135], v[200:203], a[100:103]
    ds_read_b64_tr_b16 v[126:127], v249 offset:4552
    v_mfma_f32_16x16x32_bf16 a[104:107], v[136:139], v[200:203], a[104:107]
    v_mfma_f32_16x16x32_bf16 a[108:111], v[140:143], v[200:203], a[108:111]
    ds_read_b128 v[168:171], v242 offset:4096
    v_mfma_f32_16x16x32_bf16 a[112:115], v[144:147], v[200:203], a[112:115]
    ds_read_b128 v[172:175], v242 offset:6144
    v_mfma_f32_16x16x32_bf16 a[116:119], v[148:151], v[200:203], a[116:119]
    s_add_u32 m0, s53, 73024
    s_add_u32 s52, s50, 2138112
    buffer_load_dwordx4 v15, s[20:23], s52 offen  lds
    v_mfma_f32_16x16x32_bf16 a[120:123], v[152:155], v[200:203], a[120:123]
    ds_read_b128 v[176:179], v242 offset:8192
    v_mfma_f32_16x16x32_bf16 a[124:127], v[156:159], v[200:203], a[124:127]
    ds_read_b128 v[180:183], v242 offset:10240
    v_mfma_f32_16x16x32_bf16 a[128:131], v[128:131], v[204:207], a[128:131]
    s_add_u32 m0, s53, 74112
    s_add_u32 s52, s50, 2146304
    buffer_load_dwordx4 v15, s[20:23], s52 offen  lds
    v_mfma_f32_16x16x32_bf16 a[132:135], v[132:135], v[204:207], a[132:135]
    ds_read_b128 v[184:187], v246
    v_mfma_f32_16x16x32_bf16 a[136:139], v[136:139], v[204:207], a[136:139]
    v_mfma_f32_16x16x32_bf16 a[140:143], v[140:143], v[204:207], a[140:143]
    v_mfma_f32_16x16x32_bf16 a[144:147], v[144:147], v[204:207], a[144:147]
    v_mfma_f32_16x16x32_bf16 a[148:151], v[148:151], v[204:207], a[148:151]
    s_add_u32 m0, s53, 75200
    s_add_u32 s52, s50, 2154496
    buffer_load_dwordx4 v15, s[20:23], s52 offen  lds
    v_mfma_f32_16x16x32_bf16 a[152:155], v[152:155], v[204:207], a[152:155]
    v_mfma_f32_16x16x32_bf16 a[156:159], v[156:159], v[204:207], a[156:159]
    v_mfma_f32_16x16x32_bf16 a[160:163], v[128:131], v[208:211], a[160:163]
    v_mfma_f32_16x16x32_bf16 a[164:167], v[132:135], v[208:211], a[164:167]
    s_add_u32 m0, s49, 40960
    s_add_u32 s52, s48, 512
    buffer_load_dwordx4 v250, s[16:19], s52 offen  lds
    v_mfma_f32_16x16x32_bf16 a[168:171], v[136:139], v[208:211], a[168:171]
    v_mfma_f32_16x16x32_bf16 a[172:175], v[140:143], v[208:211], a[172:175]
    v_mfma_f32_16x16x32_bf16 a[176:179], v[144:147], v[208:211], a[176:179]
    v_mfma_f32_16x16x32_bf16 a[180:183], v[148:151], v[208:211], a[180:183]
    v_mfma_f32_16x16x32_bf16 a[184:187], v[152:155], v[208:211], a[184:187]
    v_mfma_f32_16x16x32_bf16 a[188:191], v[156:159], v[208:211], a[188:191]
    s_cmp_eq_u32 s5, 0
    s_cbranch_scc0 L_q1_11
    v_mfma_f32_16x16x32_bf16 a[192:195], v[128:131], v[212:215], a[192:195]
    v_mfma_f32_16x16x32_bf16 a[196:199], v[132:135], v[212:215], a[196:199]
    v_mfma_f32_16x16x32_bf16 a[200:203], v[136:139], v[212:215], a[200:203]
    v_mfma_f32_16x16x32_bf16 a[204:207], v[140:143], v[212:215], a[204:207]
    s_branch L_q2_11
L_q1_11:
    v_mfma_f32_16x16x32_bf16 a[192:195], v[144:147], v[212:215], a[192:195]
    v_mfma_f32_16x16x32_bf16 a[196:199], v[148:151], v[212:215], a[196:199]
    v_mfma_f32_16x16x32_bf16 a[200:203], v[152:155], v[212:215], a[200:203]
    v_mfma_f32_16x16x32_bf16 a[204:207], v[156:159], v[212:215], a[204:207]
L_q2_11:
    s_waitcnt lgkmcnt(5)
    v_mfma_f32_16x16x32_bf16 a[0:3], v[96:99], v[160:163], a[0:3]
    ds_read_b128 v[188:191], v243 offset:0
    v_mfma_f32_16x16x32_bf16 a[4:7], v[100:103], v[160:163], a[4:7]
    ds_read_b64_tr_b16 v[128:129], v249 offset:8704
    s_add_u32 m0, s49, 41984
    s_add_u32 s52, s48, 10752
    buffer_load_dwordx4 v250, s[16:19], s52 offen  lds
    v_mfma_f32_16x16x32_bf16 a[8:11], v[104:107], v[160:163], a[8:11]
    ds_read_b64_tr_b16 v[130:131], v249 offset:13056
    v_mfma_f32_16x16x32_bf16 a[12:15], v[108:111], v[160:163], a[12:15]
    ds_read_b64_tr_b16 v[132:133], v249 offset:8712
    v_mfma_f32_16x16x32_bf16 a[16:19], v[112:115], v[160:163], a[16:19]
    v_mfma_f32_16x16x32_bf16 a[20:23], v[116:119], v[160:163], a[20:23]
    ds_read_b64_tr_b16 v[134:135], v249 offset:13064
    v_mfma_f32_16x16x32_bf16 a[24:27], v[120:123], v[160:163], a[24:27]
    ds_read_b64_tr_b16 v[136:137], v249 offset:8768
    v_mfma_f32_16x16x32_bf16 a[28:31], v[124:127], v[160:163], a[28:31]
    s_add_u32 m0, s49, 43008
    s_add_u32 s52, s48, 20992
    buffer_load_dwordx4 v250, s[16:19], s52 offen  lds
    v_mfma_f32_16x16x32_bf16 a[32:35], v[96:99], v[164:167], a[32:35]
    ds_read_b64_tr_b16 v[138:139], v249 offset:13120
    v_mfma_f32_16x16x32_bf16 a[36:39], v[100:103], v[164:167], a[36:39]
    ds_read_b64_tr_b16 v[140:141], v249 offset:8776
    v_mfma_f32_16x16x32_bf16 a[40:43], v[104:107], v[164:167], a[40:43]
    v_mfma_f32_16x16x32_bf16 a[44:47], v[108:111], v[164:167], a[44:47]
    ds_read_b64_tr_b16 v[142:143], v249 offset:13128
    v_mfma_f32_16x16x32_bf16 a[48:51], v[112:115], v[164:167], a[48:51]
    s_add_u32 m0, s49, 44032
    s_add_u32 s52, s48, 31232
    buffer_load_dwordx4 v250, s[16:19], s52 offen  lds
    v_mfma_f32_16x16x32_bf16 a[52:55], v[116:119], v[164:167], a[52:55]
    ds_read_b128 v[192:195], v243 offset:2048
    v_mfma_f32_16x16x32_bf16 a[56:59], v[120:123], v[164:167], a[56:59]
    ds_read_b64_tr_b16 v[144:145], v249 offset:8832
    v_mfma_f32_16x16x32_bf16 a[60:63], v[124:127], v[164:167], a[60:63]
    s_waitcnt lgkmcnt(14)
    v_mfma_f32_16x16x32_bf16 a[64:67], v[96:99], v[168:171], a[64:67]
    ds_read_b64_tr_b16 v[146:147], v249 offset:13184
    v_mfma_f32_16x16x32_bf16 a[68:71], v[100:103], v[168:171], a[68:71]
    ds_read_b64_tr_b16 v[148:149], v249 offset:8840
    v_mfma_f32_16x16x32_bf16 a[72:75], v[104:107], v[168:171], a[72:75]
    s_add_u32 m0, s49, 45056
    s_add_u32 s52, s48, 41472
    buffer_load_dwordx4 v250, s[16:19], s52 offen  lds
    v_mfma_f32_16x16x32_bf16 a[76:79], v[108:111], v[168:171], a[76:79]
    ds_read_b64_tr_b16 v[150:151], v249 offset:13192
    v_mfma_f32_16x16x32_bf16 a[80:83], v[112:115], v[168:171], a[80:83]
    ds_read_b64_tr_b16 v[152:153], v249 offset:8896
    v_mfma_f32_16x16x32_bf16 a[84:87], v[116:119], v[168:171], a[84:87]
    v_mfma_f32_16x16x32_bf16 a[88:91], v[120:123], v[168:171], a[88:91]
    ds_read_b64_tr_b16 v[154:155], v249 offset:13248
    v_mfma_f32_16x16x32_bf16 a[92:95], v[124:127], v[168:171], a[92:95]
    v_mfma_f32_16x16x32_bf16 a[96:99], v[96:99], v[172:175], a[96:99]
    ds_read_b64_tr_b16 v[156:157], v249 offset:8904
    v_mfma_f32_16x16x32_bf16 a[100:103], v[100:103], v[172:175], a[100:103]
    ds_read_b64_tr_b16 v[158:159], v249 offset:13256
    v_mfma_f32_16x16x32_bf16 a[104:107], v[104:107], v[172:175], a[104:107]
    v_mfma_f32_16x16x32_bf16 a[108:111], v[108:111], v[172:175], a[108:111]
    ds_read_b128 v[196:199], v243 offset:4096
    v_mfma_f32_16x16x32_bf16 a[112:115], v[112:115], v[172:175], a[112:115]
    ds_read_b128 v[200:203], v243 offset:6144
    v_mfma_f32_16x16x32_bf16 a[116:119], v[116:119], v[172:175], a[116:119]
    v_mfma_f32_16x16x32_bf16 a[120:123], v[120:123], v[172:175], a[120:123]
    ds_read_b128 v[204:207], v243 offset:8192
    v_mfma_f32_16x16x32_bf16 a[124:127], v[124:127], v[172:175], a[124:127]
    ds_read_b128 v[208:211], v243 offset:10240
    s_waitcnt lgkmcnt(15)
    v_mfma_f32_16x16x32_bf16 a[128:131], v[96:99], v[176:179], a[128:131]
    v_mfma_f32_16x16x32_bf16 a[132:135], v[100:103], v[176:179], a[132:135]
    ds_read_b128 v[212:215], v247
    v_mfma_f32_16x16x32_bf16 a[136:139], v[104:107], v[176:179], a[136:139]
    v_mfma_f32_16x16x32_bf16 a[140:143], v[108:111], v[176:179], a[140:143]
    v_mfma_f32_16x16x32_bf16 a[144:147], v[112:115], v[176:179], a[144:147]
    v_mfma_f32_16x16x32_bf16 a[148:151], v[116:119], v[176:179], a[148:151]
    v_mfma_f32_16x16x32_bf16 a[152:155], v[120:123], v[176:179], a[152:155]
    v_mfma_f32_16x16x32_bf16 a[156:159], v[124:127], v[176:179], a[156:159]
    v_mfma_f32_16x16x32_bf16 a[160:163], v[96:99], v[180:183], a[160:163]
    v_mfma_f32_16x16x32_bf16 a[164:167], v[100:103], v[180:183], a[164:167]
    v_mfma_f32_16x16x32_bf16 a[168:171], v[104:107], v[180:183], a[168:171]
    v_mfma_f32_16x16x32_bf16 a[172:175], v[108:111], v[180:183], a[172:175]
    v_mfma_f32_16x16x32_bf16 a[176:179], v[112:115], v[180:183], a[176:179]
    v_mfma_f32_16x16x32_bf16 a[180:183], v[116:119], v[180:183], a[180:183]
    v_mfma_f32_16x16x32_bf16 a[184:187], v[120:123], v[180:183], a[184:187]
    v_mfma_f32_16x16x32_bf16 a[188:191], v[124:127], v[180:183], a[188:191]
    s_cmp_eq_u32 s5, 0
    s_cbranch_scc0 L_q1_12
    v_mfma_f32_16x16x32_bf16 a[192:195], v[96:99], v[184:187], a[192:195]
    v_mfma_f32_16x16x32_bf16 a[196:199], v[100:103], v[184:187], a[196:199]
    v_mfma_f32_16x16x32_bf16 a[200:203], v[104:107], v[184:187], a[200:203]
    v_mfma_f32_16x16x32_bf16 a[204:207], v[108:111], v[184:187], a[204:207]
    s_branch L_q2_12
L_q1_12:
    v_mfma_f32_16x16x32_bf16 a[192:195], v[112:115], v[184:187], a[192:195]
    v_mfma_f32_16x16x32_bf16 a[196:199], v[116:119], v[184:187], a[196:199]
    v_mfma_f32_16x16x32_bf16 a[200:203], v[120:123], v[184:187], a[200:203]
    v_mfma_f32_16x16x32_bf16 a[204:207], v[124:127], v[184:187], a[204:207]
L_q2_12:
    s_waitcnt vmcnt(0) lgkmcnt(0)
    s_barrier
    v_mfma_f32_16x16x32_bf16 a[0:3], v[128:131], v[188:191], a[0:3]
    ds_read_b128 v[160:163], v240 offset:0
    v_mfma_f32_16x16x32_bf16 a[4:7], v[132:135], v[188:191], a[4:7]
    ds_read_b64_tr_b16 v[96:97], v248 offset:0
    v_mfma_f32_16x16x32_bf16 a[8:11], v[136:139], v[188:191], a[8:11]
    ds_read_b64_tr_b16 v[98:99], v248 offset:4352
    s_cmp_eq_u32 s3, 3
    s_cbranch_scc1 L_xs13
    s_add_u32 m0, s49, 107520
    s_add_u32 s52, s48, 51840
    buffer_load_dwordx4 v250, s[16:19], s52 offen  lds
    s_add_u32 m0, s49, 108544
    s_add_u32 s52, s48, 62080
    buffer_load_dwordx4 v250, s[16:19], s52 offen  lds
L_xs13:
    v_mfma_f32_16x16x32_bf16 a[12:15], v[140:143], v[188:191], a[12:15]
    ds_read_b64_tr_b16 v[100:101], v248 offset:8
    v_mfma_f32_16x16x32_bf16 a[16:19], v[144:147], v[188:191], a[16:19]
    v_mfma_f32_16x16x32_bf16 a[20:23], v[148:151], v[188:191], a[20:23]
    ds_read_b64_tr_b16 v[102:103], v248 offset:4360
    v_mfma_f32_16x16x32_bf16 a[24:27], v[152:155], v[188:191], a[24:27]
    ds_read_b64_tr_b16 v[104:105], v248 offset:64
    v_mfma_f32_16x16x32_bf16 a[28:31], v[156:159], v[188:191], a[28:31]
    s_add_u32 m0, s53, 129024
    s_add_u32 s52, s50, 2621440
    buffer_load_dwordx4 v15, s[20:23], s52 offen  lds
    v_mfma_f32_16x16x32_bf16 a[32:35], v[128:131], v[192:195], a[32:35]
    ds_read_b64_tr_b16 v[106:107], v248 offset:4416
    v_mfma_f32_16x16x32_bf16 a[36:39], v[132:135], v[192:195], a[36:39]
    ds_read_b64_tr_b16 v[108:109], v248 offset:72
    v_mfma_f32_16x16x32_bf16 a[40:43], v[136:139], v[192:195], a[40:43]
    s_add_u32 m0, s53, 130112
    s_add_u32 s52, s50, 2629632
    buffer_load_dwordx4 v15, s[20:23], s52 offen  lds
    v_mfma_f32_16x16x32_bf16 a[44:47], v[140:143], v[192:195], a[44:47]
    ds_read_b64_tr_b16 v[110:111], v248 offset:4424
    v_mfma_f32_16x16x32_bf16 a[48:51], v[144:147], v[192:195], a[48:51]
    v_mfma_f32_16x16x32_bf16 a[52:55], v[148:151], v[192:195], a[52:55]
    ds_read_b128 v[164:167], v240 offset:2048
    v_mfma_f32_16x16x32_bf16 a[56:59], v[152:155], v[192:195], a[56:59]
    ds_read_b64_tr_b16 v[112:113], v248 offset:128
    v_mfma_f32_16x16x32_bf16 a[60:63], v[156:159], v[192:195], a[60:63]
    s_add_u32 m0, s53, 131200
    s_add_u32 s52, s50, 2637824
    buffer_load_dwordx4 v15, s[20:23], s52 offen  lds
    v_mfma_f32_16x16x32_bf16 a[64:67], v[128:131], v[196:199], a[64:67]
    ds_read_b64_tr_b16 v[114:115], v248 offset:4480
    v_mfma_f32_16x16x32_bf16 a[68:71], v[132:135], v[196:199], a[68:71]
    ds_read_b64_tr_b16 v[116:117], v248 offset:136
    v_mfma_f32_16x16x32_bf16 a[72:75], v[136:139], v[196:199], a[72:75]
    v_mfma_f32_16x16x32_bf16 a[76:79], v[140:143], v[196:199], a[76:79]
    ds_read_b64_tr_b16 v[118:119], v248 offset:4488
    v_mfma_f32_16x16x32_bf16 a[80:83], v[144:147], v[196:199], a[80:83]
    ds_read_b64_tr_b16 v[120:121], v248 offset:192
    ds_read_b64_tr_b16 v[16:17], v12 offset:0
    v_mfma_f32_16x16x32_bf16 a[84:87], v[148:151], v[196:199], a[84:87]
    s_add_u32 m0, s53, 132288
    s_add_u32 s52, s50, 2646016
    buffer_load_dwordx4 v15, s[20:23], s52 offen  lds
    v_mfma_f32_16x16x32_bf16 a[88:91], v[152:155], v[196:199], a[88:91]
    ds_read_b64_tr_b16 v[122:123], v248 offset:4544
    ds_read_b64_tr_b16 v[18:19], v12 offset:20480
    ds_read_b64_tr_b16 v[20:21], v12 offset:8
    v_mfma_f32_16x16x32_bf16 a[92:95], v[156:159], v[196:199], a[92:95]
    s_add_u32 m0, s53, 133376
    s_add_u32 s52, s50, 2654208
    buffer_load_dwordx4 v15, s[20:23], s52 offen  lds
    v_mfma_f32_16x16x32_bf16 a[96:99], v[128:131], v[200:203], a[96:99]
    ds_read_b64_tr_b16 v[124:125], v248 offset:200
    ds_read_b64_tr_b16 v[22:23], v12 offset:20488
    v_mfma_f32_16x16x32_bf16 a[100:103], v[132:135], v[200:203], a[100:103]
    ds_read_b64_tr_b16 v[126:127], v248 offset:4552
    v_mfma_f32_16x16x32_bf16 a[104:107], v[136:139], v[200:203], a[104:107]
    ds_read_b64_tr_b16 v[24:25], v12 offset:64
    ds_read_b64_tr_b16 v[26:27], v12 offset:20544
    v_mfma_f32_16x16x32_bf16 a[108:111], v[140:143], v[200:203], a[108:111]
    ds_read_b128 v[168:171], v240 offset:4096
    ds_read_b64_tr_b16 v[28:29], v12 offset:72
    v_mfma_f32_16x16x32_bf16 a[112:115], v[144:147], v[200:203], a[112:115]
    ds_read_b128 v[172:175], v240 offset:6144
    ds_read_b64_tr_b16 v[30:31], v12 offset:20552
    v_mfma_f32_16x16x32_bf16 a[116:119], v[148:151], v[200:203], a[116:119]
    s_add_u32 m0, s53, 134464
    s_add_u32 s52, s50, 2662400
    buffer_load_dwordx4 v15, s[20:23], s52 offen  lds
    v_mfma_f32_16x16x32_bf16 a[120:123], v[152:155], v[200:203], a[120:123]
    ds_read_b128 v[176:179], v240 offset:8192
    ds_read_b64_tr_b16 v[32:33], v13 offset:128
    v_mfma_f32_16x16x32_bf16 a[124:127], v[156:159], v[200:203], a[124:127]
    ds_read_b128 v[180:183], v240 offset:10240
    ds_read_b64_tr_b16 v[34:35], v13 offset:20608
    v_mfma_f32_16x16x32_bf16 a[128:131], v[128:131], v[204:207], a[128:131]
    s_add_u32 m0, s53, 135552
    s_add_u32 s52, s50, 2670592
    buffer_load_dwordx4 v15, s[20:23], s52 offen  lds
    v_mfma_f32_16x16x32_bf16 a[132:135], v[132:135], v[204:207], a[132:135]
    ds_read_b128 v[184:187], v244
    v_mfma_f32_16x16x32_bf16 a[136:139], v[136:139], v[204:207], a[136:139]
    ds_read_b64_tr_b16 v[36:37], v12 offset:160
    v_mfma_f32_16x16x32_bf16 a[140:143], v[140:143], v[204:207], a[140:143]
    ds_read_b64_tr_b16 v[38:39], v12 offset:20640
    v_mfma_f32_16x16x32_bf16 a[144:147], v[144:147], v[204:207], a[144:147]
    ds_read_b64_tr_b16 v[40:41], v12 offset:168
    v_mfma_f32_16x16x32_bf16 a[148:151], v[148:151], v[204:207], a[148:151]
    s_add_u32 m0, s53, 136640
    s_add_u32 s52, s50, 2678784
    buffer_load_dwordx4 v15, s[20:23], s52 offen  lds
    v_mfma_f32_16x16x32_bf16 a[152:155], v[152:155], v[204:207], a[152:155]
    ds_read_b64_tr_b16 v[42:43], v12 offset:20648
    v_mfma_f32_16x16x32_bf16 a[156:159], v[156:159], v[204:207], a[156:159]
    ds_read_b64_tr_b16 v[44:45], v12 offset:224
    v_mfma_f32_16x16x32_bf16 a[160:163], v[128:131], v[208:211], a[160:163]
    ds_read_b64_tr_b16 v[46:47], v12 offset:20704
    v_mfma_f32_16x16x32_bf16 a[164:167], v[132:135], v[208:211], a[164:167]
    s_add_u32 m0, s49, 102400
    s_add_u32 s52, s48, 640
    buffer_load_dwordx4 v250, s[16:19], s52 offen  lds
    v_mfma_f32_16x16x32_bf16 a[168:171], v[136:139], v[208:211], a[168:171]
    ds_read_b64_tr_b16 v[48:49], v12 offset:232
    v_mfma_f32_16x16x32_bf16 a[172:175], v[140:143], v[208:211], a[172:175]
    ds_read_b64_tr_b16 v[50:51], v12 offset:20712
    v_mfma_f32_16x16x32_bf16 a[176:179], v[144:147], v[208:211], a[176:179]
    ds_read_b64_tr_b16 v[52:53], v13 offset:288
    v_mfma_f32_16x16x32_bf16 a[180:183], v[148:151], v[208:211], a[180:183]
    ds_read_b64_tr_b16 v[54:55], v13 offset:20768
    v_mfma_f32_16x16x32_bf16 a[184:187], v[152:155], v[208:211], a[184:187]
    v_mfma_f32_16x16x32_bf16 a[188:191], v[156:159], v[208:211], a[188:191]
    s_cmp_eq_u32 s5, 0
    s_cbranch_scc0 L_q1_14
    v_mfma_f32_16x16x32_bf16 a[192:195], v[128:131], v[212:215], a[192:195]
    v_mfma_f32_16x16x32_bf16 a[196:199], v[132:135], v[212:215], a[196:199]
    v_mfma_f32_16x16x32_bf16 a[200:203], v[136:139], v[212:215], a[200:203]
    v_mfma_f32_16x16x32_bf16 a[204:207], v[140:143], v[212:215], a[204:207]
    s_branch L_q2_14
L_q1_14:
    v_mfma_f32_16x16x32_bf16 a[192:195], v[144:147], v[212:215], a[192:195]
    v_mfma_f32_16x16x32_bf16 a[196:199], v[148:151], v[212:215], a[196:199]
    v_mfma_f32_16x16x32_bf16 a[200:203], v[152:155], v[212:215], a[200:203]
    v_mfma_f32_16x16x32_bf16 a[204:207], v[156:159], v[212:215], a[204:207]
L_q2_14:
    s_waitcnt lgkmcnt(15)
    v_mfma_f32_16x16x32_bf16 a[0:3], v[96:99], v[160:163], a[0:3]
    ds_read_b128 v[188:191], v241 offset:0
    v_mfma_f32_16x16x32_bf16 a[4:7], v[100:103], v[160:163], a[4:7]
    ds_read_b64_tr_b16 v[128:129], v248 offset:8704
    s_add_u32 m0, s49, 103424
    s_add_u32 s52, s48, 10880
    buffer_load_dwordx4 v250, s[16:19], s52 offen  lds
    v_mfma_f32_16x16x32_bf16 a[8:11], v[104:107], v[160:163], a[8:11]
    ds_read_b64_tr_b16 v[130:131], v248 offset:13056
    v_mfma_f32_16x16x32_bf16 a[12:15], v[108:111], v[160:163], a[12:15]
    ds_read_b64_tr_b16 v[132:133], v248 offset:8712
    v_mfma_f32_16x16x32_bf16 a[16:19], v[112:115], v[160:163], a[16:19]
    v_mfma_f32_16x16x32_bf16 a[20:23], v[116:119], v[160:163], a[20:23]
    ds_read_b64_tr_b16 v[134:135], v248 offset:13064
    v_mfma_f32_16x16x32_bf16 a[24:27], v[120:123], v[160:163], a[24:27]
    ds_read_b64_tr_b16 v[136:137], v248 offset:8768
    v_mfma_f32_16x16x32_bf16 a[28:31], v[124:127], v[160:163], a[28:31]
    s_add_u32 m0, s49, 104448
    s_add_u32 s52, s48, 21120
    buffer_load_dwordx4 v250, s[16:19], s52 offen  lds
    v_mfma_f32_16x16x32_bf16 a[32:35], v[96:99], v[164:167], a[32:35]
    ds_read_b64_tr_b16 v[138:139], v248 offset:13120
    v_mfma_f32_16x16x32_bf16 a[36:39], v[100:103], v[164:167], a[36:39]
    ds_read_b64_tr_b16 v[140:141], v248 offset:8776
    v_mfma_f32_16x16x32_bf16 a[40:43], v[104:107], v[164:167], a[40:43]
    v_mfma_f32_16x16x32_bf16 a[44:47], v[108:111], v[164:167], a[44:47]
    ds_read_b64_tr_b16 v[142:143], v248 offset:13128
    v_mfma_f32_16x16x32_bf16 a[48:51], v[112:115], v[164:167], a[48:51]
    s_add_u32 m0, s49, 105472
    s_add_u32 s52, s48, 31360
    buffer_load_dwordx4 v250, s[16:19], s52 offen  lds
    v_mfma_f32_16x16x32_bf16 a[52:55], v[116:119], v[164:167], a[52:55]
    ds_read_b128 v[192:195], v241 offset:2048
    v_mfma_f32_16x16x32_bf16 a[56:59], v[120:123], v[164:167], a[56:59]
    ds_read_b64_tr_b16 v[144:145], v248 offset:8832
    v_mfma_f32_16x16x32_bf16 a[60:63], v[124:127], v[164:167], a[60:63]
    v_mfma_f32_16x16x32_bf16 a[64:67], v[96:99], v[168:171], a[64:67]
    ds_read_b64_tr_b16 v[146:147], v248 offset:13184
    v_mfma_f32_16x16x32_bf16 a[68:71], v[100:103], v[168:171], a[68:71]
    ds_read_b64_tr_b16 v[148:149], v248 offset:8840
    v_mfma_f32_16x16x32_bf16 a[72:75], v[104:107], v[168:171], a[72:75]
    s_add_u32 m0, s49, 106496
    s_add_u32 s52, s48, 41600
    buffer_load_dwordx4 v250, s[16:19], s52 offen  lds
    v_mfma_f32_16x16x32_bf16 a[76:79], v[108:111], v[168:171], a[76:79]
    ds_read_b64_tr_b16 v[150:151], v248 offset:13192
    v_mfma_f32_16x16x32_bf16 a[80:83], v[112:115], v[168:171], a[80:83]
    ds_read_b64_tr_b16 v[152:153], v248 offset:8896
    v_mfma_f32_16x16x32_bf16 a[84:87], v[116:119], v[168:171], a[84:87]
    v_mfma_f32_16x16x32_bf16 a[88:91], v[120:123], v[168:171], a[88:91]
    ds_read_b64_tr_b16 v[154:155], v248 offset:13248
    v_mfma_f32_16x16x32_bf16 a[92:95], v[124:127], v[168:171], a[92:95]
    v_mfma_f32_16x16x32_bf16 a[96:99], v[96:99], v[172:175], a[96:99]
    ds_read_b64_tr_b16 v[156:157], v248 offset:8904
    s_movk_i32 s11, 0
    buffer_store_dwordx4 v[16:19], v14, s[32:35], s11 offen sc1
    v_mfma_f32_16x16x32_bf16 a[100:103], v[100:103], v[172:175], a[100:103]
    ds_read_b64_tr_b16 v[158:159], v248 offset:13256
    v_mfma_f32_16x16x32_bf16 a[104:107], v[104:107], v[172:175], a[104:107]
    s_movk_i32 s11, 1024
    buffer_store_dwordx4 v[20:23], v14, s[32:35], s11 offen sc1
    v_mfma_f32_16x16x32_bf16 a[108:111], v[108:111], v[172:175], a[108:111]
    ds_read_b128 v[196:199], v241 offset:4096
    v_mfma_f32_16x16x32_bf16 a[112:115], v[112:115], v[172:175], a[112:115]
    ds_read_b128 v[200:203], v241 offset:6144
    v_mfma_f32_16x16x32_bf16 a[116:119], v[116:119], v[172:175], a[116:119]
    s_movk_i32 s11, 2048
    buffer_store_dwordx4 v[24:27], v14, s[32:35], s11 offen sc1
    v_mfma_f32_16x16x32_bf16 a[120:123], v[120:123], v[172:175], a[120:123]
    ds_read_b128 v[204:207], v241 offset:8192
    s_movk_i32 s11, 3072
    buffer_store_dwordx4 v[28:31], v14, s[32:35], s11 offen sc1
    v_mfma_f32_16x16x32_bf16 a[124:127], v[124:127], v[172:175], a[124:127]
    ds_read_b128 v[208:211], v241 offset:10240
    s_waitcnt lgkmcnt(15)
    v_mfma_f32_16x16x32_bf16 a[128:131], v[96:99], v[176:179], a[128:131]
    s_movk_i32 s11, 4096
    buffer_store_dwordx4 v[32:35], v14, s[32:35], s11 offen sc1
    v_mfma_f32_16x16x32_bf16 a[132:135], v[100:103], v[176:179], a[132:135]
    ds_read_b128 v[212:215], v245
    v_mfma_f32_16x16x32_bf16 a[136:139], v[104:107], v[176:179], a[136:139]
    s_movk_i32 s11, 5120
    buffer_store_dwordx4 v[36:39], v14, s[32:35], s11 offen sc1
    v_mfma_f32_16x16x32_bf16 a[140:143], v[108:111], v[176:179], a[140:143]
    v_mfma_f32_16x16x32_bf16 a[144:147], v[112:115], v[176:179], a[144:147]
    s_movk_i32 s11, 6144
    buffer_store_dwordx4 v[40:43], v14, s[32:35], s11 offen sc1
    v_mfma_f32_16x16x32_bf16 a[148:151], v[116:119], v[176:179], a[148:151]
    v_mfma_f32_16x16x32_bf16 a[152:155], v[120:123], v[176:179], a[152:155]
    v_mfma_f32_16x16x32_bf16 a[156:159], v[124:127], v[176:179], a[156:159]
    s_movk_i32 s11, 7168
    buffer_store_dwordx4 v[44:47], v14, s[32:35], s11 offen sc1
    v_mfma_f32_16x16x32_bf16 a[160:163], v[96:99], v[180:183], a[160:163]
    v_mfma_f32_16x16x32_bf16 a[164:167], v[100:103], v[180:183], a[164:167]
    s_movk_i32 s11, 8192
    buffer_store_dwordx4 v[48:51], v14, s[32:35], s11 offen sc1
    v_mfma_f32_16x16x32_bf16 a[168:171], v[104:107], v[180:183], a[168:171]
    v_mfma_f32_16x16x32_bf16 a[172:175], v[108:111], v[180:183], a[172:175]
    s_movk_i32 s11, 9216
    buffer_store_dwordx4 v[52:55], v14, s[32:35], s11 offen sc1
    v_mfma_f32_16x16x32_bf16 a[176:179], v[112:115], v[180:183], a[176:179]
    v_mfma_f32_16x16x32_bf16 a[180:183], v[116:119], v[180:183], a[180:183]
    v_mfma_f32_16x16x32_bf16 a[184:187], v[120:123], v[180:183], a[184:187]
    v_mfma_f32_16x16x32_bf16 a[188:191], v[124:127], v[180:183], a[188:191]
    s_cmp_eq_u32 s5, 0
    s_cbranch_scc0 L_q1_15
    v_mfma_f32_16x16x32_bf16 a[192:195], v[96:99], v[184:187], a[192:195]
    v_mfma_f32_16x16x32_bf16 a[196:199], v[100:103], v[184:187], a[196:199]
    v_mfma_f32_16x16x32_bf16 a[200:203], v[104:107], v[184:187], a[200:203]
    v_mfma_f32_16x16x32_bf16 a[204:207], v[108:111], v[184:187], a[204:207]
    s_branch L_q2_15
L_q1_15:
    v_mfma_f32_16x16x32_bf16 a[192:195], v[112:115], v[184:187], a[192:195]
    v_mfma_f32_16x16x32_bf16 a[196:199], v[116:119], v[184:187], a[196:199]
    v_mfma_f32_16x16x32_bf16 a[200:203], v[120:123], v[184:187], a[200:203]
    v_mfma_f32_16x16x32_bf16 a[204:207], v[124:127], v[184:187], a[204:207]
L_q2_15:
    s_waitcnt vmcnt(10) lgkmcnt(0)
    s_barrier
    v_mfma_f32_16x16x32_bf16 a[0:3], v[128:131], v[188:191], a[0:3]
    ds_read_b128 v[160:163], v242 offset:0
    v_mfma_f32_16x16x32_bf16 a[4:7], v[132:135], v[188:191], a[4:7]
    ds_read_b64_tr_b16 v[96:97], v249 offset:0
    v_mfma_f32_16x16x32_bf16 a[8:11], v[136:139], v[188:191], a[8:11]
    ds_read_b64_tr_b16 v[98:99], v249 offset:4352
    s_cmp_eq_u32 s3, 3
    s_cbranch_scc1 L_xs16
    s_add_u32 m0, s49, 46080
    s_add_u32 s52, s48, 51968
    buffer_load_dwordx4 v250, s[16:19], s52 offen  lds
    s_add_u32 m0, s49, 47104
    s_add_u32 s52, s48, 62208
    buffer_load_dwordx4 v250, s[16:19], s52 offen  lds
L_xs16:
    v_mfma_f32_16x16x32_bf16 a[12:15], v[140:143], v[188:191], a[12:15]
    ds_read_b64_tr_b16 v[100:101], v249 offset:8
    v_mfma_f32_16x16x32_bf16 a[16:19], v[144:147], v[188:191], a[16:19]
    v_mfma_f32_16x16x32_bf16 a[20:23], v[148:151], v[188:191], a[20:23]
    ds_read_b64_tr_b16 v[102:103], v249 offset:4360
    v_mfma_f32_16x16x32_bf16 a[24:27], v[152:155], v[188:191], a[24:27]
    ds_read_b64_tr_b16 v[104:105], v249 offset:64
    v_mfma_f32_16x16x32_bf16 a[28:31], v[156:159], v[188:191], a[28:31]
    s_add_u32 m0, s53, 67584
    s_add_u32 s52, s50, 3145728
    buffer_load_dwordx4 v15, s[20:23], s52 offen  lds
    v_mfma_f32_16x16x32_bf16 a[32:35], v[128:131], v[192:195], a[32:35]
    ds_read_b64_tr_b16 v[106:107], v249 offset:4416
    v_mfma_f32_16x16x32_bf16 a[36:39], v[132:135], v[192:195], a[36:39]
    ds_read_b64_tr_b16 v[108:109], v249 offset:72
    v_mfma_f32_16x16x32_bf16 a[40:43], v[136:139], v[192:195], a[40:43]
    s_add_u32 m0, s53, 68672
    s_add_u32 s52, s50, 3153920
    buffer_load_dwordx4 v15, s[20:23], s52 offen  lds
    v_mfma_f32_16x16x32_bf16 a[44:47], v[140:143], v[192:195], a[44:47]
    ds_read_b64_tr_b16 v[110:111], v249 offset:4424
    v_mfma_f32_16x16x32_bf16 a[48:51], v[144:147], v[192:195], a[48:51]
    v_mfma_f32_16x16x32_bf16 a[52:55], v[148:151], v[192:195], a[52:55]
    ds_read_b128 v[164:167], v242 offset:2048
    v_mfma_f32_16x16x32_bf16 a[56:59], v[152:155], v[192:195], a[56:59]
    ds_read_b64_tr_b16 v[112:113], v249 offset:128
    v_mfma_f32_16x16x32_bf16 a[60:63], v[156:159], v[192:195], a[60:63]
    s_add_u32 m0, s53, 69760
    s_add_u32 s52, s50, 3162112
    buffer_load_dwordx4 v15, s[20:23], s52 offen  lds
    v_mfma_f32_16x16x32_bf16 a[64:67], v[128:131], v[196:199], a[64:67]
    ds_read_b64_tr_b16 v[114:115], v249 offset:4480
    v_mfma_f32_16x16x32_bf16 a[68:71], v[132:135], v[196:199], a[68:71]
    ds_read_b64_tr_b16 v[116:117], v249 offset:136
    v_mfma_f32_16x16x32_bf16 a[72:75], v[136:139], v[196:199], a[72:75]
    v_mfma_f32_16x16x32_bf16 a[76:79], v[140:143], v[196:199], a[76:79]
    ds_read_b64_tr_b16 v[118:119], v249 offset:4488
    v_mfma_f32_16x16x32_bf16 a[80:83], v[144:147], v[196:199], a[80:83]
    ds_read_b64_tr_b16 v[120:121], v249 offset:192
    v_mfma_f32_16x16x32_bf16 a[84:87], v[148:151], v[196:199], a[84:87]
    s_add_u32 m0, s53, 70848
    s_add_u32 s52, s50, 3170304
    buffer_load_dwordx4 v15, s[20:23], s52 offen  lds
    v_mfma_f32_16x16x32_bf16 a[88:91], v[152:155], v[196:199], a[88:91]
    ds_read_b64_tr_b16 v[122:123], v249 offset:4544
    v_mfma_f32_16x16x32_bf16 a[92:95], v[156:159], v[196:199], a[92:95]
    s_add_u32 m0, s53, 71936
    s_add_u32 s52, s50, 3178496
    buffer_load_dwordx4 v15, s[20:23], s52 offen  lds
    v_mfma_f32_16x16x32_bf16 a[96:99], v[128:131], v[200:203], a[96:99]
    ds_read_b64_tr_b16 v[124:125], v249 offset:200
    v_mfma_f32_16x16x32_bf16 a[100:103], v[132:135], v[200:203], a[100:103]
    ds_read_b64_tr_b16 v[126:127], v249 offset:4552
    v_mfma_f32_16x16x32_bf16 a[104:107], v[136:139], v[200:203], a[104:107]
    v_mfma_f32_16x16x32_bf16 a[108:111], v[140:143], v[200:203], a[108:111]
    ds_read_b128 v[168:171], v242 offset:4096
    v_mfma_f32_16x16x32_bf16 a[112:115], v[144:147], v[200:203], a[112:115]
    ds_read_b128 v[172:175], v242 offset:6144
    v_mfma_f32_16x16x32_bf16 a[116:119], v[148:151], v[200:203], a[116:119]
    s_add_u32 m0, s53, 73024
    s_add_u32 s52, s50, 3186688
    buffer_load_dwordx4 v15, s[20:23], s52 offen  lds
    v_mfma_f32_16x16x32_bf16 a[120:123], v[152:155], v[200:203], a[120:123]
    ds_read_b128 v[176:179], v242 offset:8192
    v_mfma_f32_16x16x32_bf16 a[124:127], v[156:159], v[200:203], a[124:127]
    ds_read_b128 v[180:183], v242 offset:10240
    v_mfma_f32_16x16x32_bf16 a[128:131], v[128:131], v[204:207], a[128:131]
    s_add_u32 m0, s53, 74112
    s_add_u32 s52, s50, 3194880
    buffer_load_dwordx4 v15, s[20:23], s52 offen  lds
    v_mfma_f32_16x16x32_bf16 a[132:135], v[132:135], v[204:207], a[132:135]
    ds_read_b128 v[184:187], v246
    v_mfma_f32_16x16x32_bf16 a[136:139], v[136:139], v[204:207], a[136:139]
    v_mfma_f32_16x16x32_bf16 a[140:143], v[140:143], v[204:207], a[140:143]
    v_mfma_f32_16x16x32_bf16 a[144:147], v[144:147], v[204:207], a[144:147]
    v_mfma_f32_16x16x32_bf16 a[148:151], v[148:151], v[204:207], a[148:151]
    s_add_u32 m0, s53, 75200
    s_add_u32 s52, s50, 3203072
    buffer_load_dwordx4 v15, s[20:23], s52 offen  lds
    v_mfma_f32_16x16x32_bf16 a[152:155], v[152:155], v[204:207], a[152:155]
    v_mfma_f32_16x16x32_bf16 a[156:159], v[156:159], v[204:207], a[156:159]
    v_mfma_f32_16x16x32_bf16 a[160:163], v[128:131], v[208:211], a[160:163]
    v_mfma_f32_16x16x32_bf16 a[164:167], v[132:135], v[208:211], a[164:167]
    s_add_u32 m0, s49, 40960
    s_add_u32 s52, s48, 768
    buffer_load_dwordx4 v250, s[16:19], s52 offen  lds
    v_mfma_f32_16x16x32_bf16 a[168:171], v[136:139], v[208:211], a[168:171]
    v_mfma_f32_16x16x32_bf16 a[172:175], v[140:143], v[208:211], a[172:175]
    v_mfma_f32_16x16x32_bf16 a[176:179], v[144:147], v[208:211], a[176:179]
    v_mfma_f32_16x16x32_bf16 a[180:183], v[148:151], v[208:211], a[180:183]
    v_mfma_f32_16x16x32_bf16 a[184:187], v[152:155], v[208:211], a[184:187]
    v_mfma_f32_16x16x32_bf16 a[188:191], v[156:159], v[208:211], a[188:191]
    s_cmp_eq_u32 s5, 0
    s_cbranch_scc0 L_q1_17
    v_mfma_f32_16x16x32_bf16 a[192:195], v[128:131], v[212:215], a[192:195]
    v_mfma_f32_16x16x32_bf16 a[196:199], v[132:135], v[212:215], a[196:199]
    v_mfma_f32_16x16x32_bf16 a[200:203], v[136:139], v[212:215], a[200:203]
    v_mfma_f32_16x16x32_bf16 a[204:207], v[140:143], v[212:215], a[204:207]
    s_branch L_q2_17
L_q1_17:
    v_mfma_f32_16x16x32_bf16 a[192:195], v[144:147], v[212:215], a[192:195]
    v_mfma_f32_16x16x32_bf16 a[196:199], v[148:151], v[212:215], a[196:199]
    v_mfma_f32_16x16x32_bf16 a[200:203], v[152:155], v[212:215], a[200:203]
    v_mfma_f32_16x16x32_bf16 a[204:207], v[156:159], v[212:215], a[204:207]
L_q2_17:
    s_waitcnt lgkmcnt(5)
    v_mfma_f32_16x16x32_bf16 a[0:3], v[96:99], v[160:163], a[0:3]
    ds_read_b128 v[188:191], v243 offset:0
    v_mfma_f32_16x16x32_bf16 a[4:7], v[100:103], v[160:163], a[4:7]
    ds_read_b64_tr_b16 v[128:129], v249 offset:8704
    s_add_u32 m0, s49, 41984
    s_add_u32 s52, s48, 11008
    buffer_load_dwordx4 v250, s[16:19], s52 offen  lds
    v_mfma_f32_16x16x32_bf16 a[8:11], v[104:107], v[160:163], a[8:11]
    ds_read_b64_tr_b16 v[130:131], v249 offset:13056
    s_add_u32 m0, s49, 43008
    s_add_u32 s52, s48, 21248
    buffer_load_dwordx4 v250, s[16:19], s52 offen  lds
    v_mfma_f32_16x16x32_bf16 a[12:15], v[108:111], v[160:163], a[12:15]
    ds_read_b64_tr_b16 v[132:133], v249 offset:8712
    v_mfma_f32_16x16x32_bf16 a[16:19], v[112:115], v[160:163], a[16:19]
    s_add_u32 m0, s49, 44032
    s_add_u32 s52, s48, 31488
    buffer_load_dwordx4 v250, s[16:19], s52 offen  lds
    v_mfma_f32_16x16x32_bf16 a[20:23], v[116:119], v[160:163], a[20:23]
    ds_read_b64_tr_b16 v[134:135], v249 offset:13064
    v_mfma_f32_16x16x32_bf16 a[24:27], v[120:123], v[160:163], a[24:27]
    ds_read_b64_tr_b16 v[136:137], v249 offset:8768
    v_mfma_f32_16x16x32_bf16 a[28:31], v[124:127], v[160:163], a[28:31]
    s_add_u32 m0, s49, 45056
    s_add_u32 s52, s48, 41728
    buffer_load_dwordx4 v250, s[16:19], s52 offen  lds
    v_mfma_f32_16x16x32_bf16 a[32:35], v[96:99], v[164:167], a[32:35]
    ds_read_b64_tr_b16 v[138:139], v249 offset:13120
    s_add_u32 m0, s38, 0
    s_nop 0
    buffer_load_dwordx4 v6, s[12:15], s37 offen offset:0 nt lds
    v_mfma_f32_16x16x32_bf16 a[36:39], v[100:103], v[164:167], a[36:39]
    ds_read_b64_tr_b16 v[140:141], v249 offset:8776
    v_mfma_f32_16x16x32_bf16 a[40:43], v[104:107], v[164:167], a[40:43]
    s_add_u32 m0, s38, 800
    s_nop 0
    buffer_load_dwordx4 v6, s[12:15], s37 offen offset:256 nt lds
    v_mfma_f32_16x16x32_bf16 a[44:47], v[108:111], v[164:167], a[44:47]
    ds_read_b64_tr_b16 v[142:143], v249 offset:13128
    v_mfma_f32_16x16x32_bf16 a[48:51], v[112:115], v[164:167], a[48:51]
    s_add_u32 m0, s38, 1600
    s_nop 0
    buffer_load_dwordx4 v6, s[12:15], s37 offen offset:512 nt lds
    v_mfma_f32_16x16x32_bf16 a[52:55], v[116:119], v[164:167], a[52:55]
    ds_read_b128 v[192:195], v243 offset:2048
    s_add_u32 m0, s38, 2400
    s_nop 0
    buffer_load_dwordx4 v6, s[12:15], s37 offen offset:768 nt lds
    v_mfma_f32_16x16x32_bf16 a[56:59], v[120:123], v[164:167], a[56:59]
    ds_read_b64_tr_b16 v[144:145], v249 offset:8832
    v_mfma_f32_16x16x32_bf16 a[60:63], v[124:127], v[164:167], a[60:63]
    s_add_u32 m0, s38, 3200
    s_nop 0
    buffer_load_dwordx4 v6, s[12:15], s37 offen offset:1024 nt lds
    s_waitcnt lgkmcnt(14)
    v_mfma_f32_16x16x32_bf16 a[64:67], v[96:99], v[168:171], a[64:67]
    ds_read_b64_tr_b16 v[146:147], v249 offset:13184
    s_add_u32 m0, s38, 4000
    s_nop 0
    buffer_load_dwordx4 v6, s[12:15], s37 offen offset:1280 nt lds
    v_mfma_f32_16x16x32_bf16 a[68:71], v[100:103], v[168:171], a[68:71]
    ds_read_b64_tr_b16 v[148:149], v249 offset:8840
    v_mfma_f32_16x16x32_bf16 a[72:75], v[104:107], v[168:171], a[72:75]
    s_add_u32 m0, s38, 4800
    s_nop 0
    buffer_load_dwordx4 v6, s[12:15], s37 offen offset:1536 nt lds
    v_mfma_f32_16x16x32_bf16 a[76:79], v[108:111], v[168:171], a[76:79]
    ds_read_b64_tr_b16 v[150:151], v249 offset:13192
    v_mfma_f32_16x16x32_bf16 a[80:83], v[112:115], v[168:171], a[80:83]
    ds_read_b64_tr_b16 v[152:153], v249 offset:8896
    v_mfma_f32_16x16x32_bf16 a[84:87], v[116:119], v[168:171], a[84:87]
    s_add_u32 m0, s38, 5600
    s_nop 0
    buffer_load_dwordx4 v6, s[12:15], s37 offen offset:1792 nt lds
    v_mfma_f32_16x16x32_bf16 a[88:91], v[120:123], v[168:171], a[88:91]
    ds_read_b64_tr_b16 v[154:155], v249 offset:13248
    v_mfma_f32_16x16x32_bf16 a[92:95], v[124:127], v[168:171], a[92:95]
    s_add_u32 s37, s37, 8192
        s_add_u32 s38, s38, 33792
        s_cmp_ge_u32 s38, s42
        s_cselect_b32 s38, s41, s38
    v_mfma_f32_16x16x32_bf16 a[96:99], v[96:99], v[172:175], a[96:99]
    ds_read_b64_tr_b16 v[156:157], v249 offset:8904
    v_mfma_f32_16x16x32_bf16 a[100:103], v[100:103], v[172:175], a[100:103]
    ds_read_b64_tr_b16 v[158:159], v249 offset:13256
    v_mfma_f32_16x16x32_bf16 a[104:107], v[104:107], v[172:175], a[104:107]
    v_mfma_f32_16x16x32_bf16 a[108:111], v[108:111], v[172:175], a[108:111]
    ds_read_b128 v[196:199], v243 offset:4096
    v_mfma_f32_16x16x32_bf16 a[112:115], v[112:115], v[172:175], a[112:115]
    ds_read_b128 v[200:203], v243 offset:6144
    v_mfma_f32_16x16x32_bf16 a[116:119], v[116:119], v[172:175], a[116:119]
    v_mfma_f32_16x16x32_bf16 a[120:123], v[120:123], v[172:175], a[120:123]
    ds_read_b128 v[204:207], v243 offset:8192
    v_mfma_f32_16x16x32_bf16 a[124:127], v[124:127], v[172:175], a[124:127]
    ds_read_b128 v[208:211], v243 offset:10240
    s_waitcnt lgkmcnt(15)
    v_mfma_f32_16x16x32_bf16 a[128:131], v[96:99], v[176:179], a[128:131]
    v_mfma_f32_16x16x32_bf16 a[132:135], v[100:103], v[176:179], a[132:135]
    ds_read_b128 v[212:215], v247
    v_mfma_f32_16x16x32_bf16 a[136:139], v[104:107], v[176:179], a[136:139]
    v_mfma_f32_16x16x32_bf16 a[140:143], v[108:111], v[176:179], a[140:143]
    v_mfma_f32_16x16x32_bf16 a[144:147], v[112:115], v[176:179], a[144:147]
    v_mfma_f32_16x16x32_bf16 a[148:151], v[116:119], v[176:179], a[148:151]
    v_mfma_f32_16x16x32_bf16 a[152:155], v[120:123], v[176:179], a[152:155]
    v_mfma_f32_16x16x32_bf16 a[156:159], v[124:127], v[176:179], a[156:159]
    v_mfma_f32_16x16x32_bf16 a[160:163], v[96:99], v[180:183], a[160:163]
    v_mfma_f32_16x16x32_bf16 a[164:167], v[100:103], v[180:183], a[164:167]
    v_mfma_f32_16x16x32_bf16 a[168:171], v[104:107], v[180:183], a[168:171]
    v_mfma_f32_16x16x32_bf16 a[172:175], v[108:111], v[180:183], a[172:175]
    v_mfma_f32_16x16x32_bf16 a[176:179], v[112:115], v[180:183], a[176:179]
    v_mfma_f32_16x16x32_bf16 a[180:183], v[116:119], v[180:183], a[180:183]
    v_mfma_f32_16x16x32_bf16 a[184:187], v[120:123], v[180:183], a[184:187]
    v_mfma_f32_16x16x32_bf16 a[188:191], v[124:127], v[180:183], a[188:191]
    s_cmp_eq_u32 s5, 0
    s_cbranch_scc0 L_q1_18
    v_mfma_f32_16x16x32_bf16 a[192:195], v[96:99], v[184:187], a[192:195]
    v_mfma_f32_16x16x32_bf16 a[196:199], v[100:103], v[184:187], a[196:199]
    v_mfma_f32_16x16x32_bf16 a[200:203], v[104:107], v[184:187], a[200:203]
    v_mfma_f32_16x16x32_bf16 a[204:207], v[108:111], v[184:187], a[204:207]
    s_branch L_q2_18
L_q1_18:
    v_mfma_f32_16x16x32_bf16 a[192:195], v[112:115], v[184:187], a[192:195]
    v_mfma_f32_16x16x32_bf16 a[196:199], v[116:119], v[184:187], a[196:199]
    v_mfma_f32_16x16x32_bf16 a[200:203], v[120:123], v[184:187], a[200:203]
    v_mfma_f32_16x16x32_bf16 a[204:207], v[124:127], v[184:187], a[204:207]
L_q2_18:
    s_waitcnt vmcnt(8) lgkmcnt(0)
    s_barrier
    v_mfma_f32_16x16x32_bf16 a[0:3], v[128:131], v[188:191], a[0:3]
    ds_read_b128 v[160:163], v240 offset:0
    v_mfma_f32_16x16x32_bf16 a[4:7], v[132:135], v[188:191], a[4:7]
    ds_read_b64_tr_b16 v[96:97], v248 offset:0
    v_mfma_f32_16x16x32_bf16 a[8:11], v[136:139], v[188:191], a[8:11]
    ds_read_b64_tr_b16 v[98:99], v248 offset:4352
    s_cmp_eq_u32 s3, 3
    s_cbranch_scc1 L_xs19
    s_add_u32 m0, s49, 107520
    s_add_u32 s52, s48, 52096
    buffer_load_dwordx4 v250, s[16:19], s52 offen  lds
    s_add_u32 m0, s49, 108544
    s_add_u32 s52, s48, 62336
    buffer_load_dwordx4 v250, s[16:19], s52 offen  lds
L_xs19:
    v_mfma_f32_16x16x32_bf16 a[12:15], v[140:143], v[188:191], a[12:15]
    ds_read_b64_tr_b16 v[100:101], v248 offset:8
    v_mfma_f32_16x16x32_bf16 a[16:19], v[144:147], v[188:191], a[16:19]
    v_mfma_f32_16x16x32_bf16 a[20:23], v[148:151], v[188:191], a[20:23]
    ds_read_b64_tr_b16 v[102:103], v248 offset:4360
    v_mfma_f32_16x16x32_bf16 a[24:27], v[152:155], v[188:191], a[24:27]
    ds_read_b64_tr_b16 v[104:105], v248 offset:64
    v_mfma_f32_16x16x32_bf16 a[28:31], v[156:159], v[188:191], a[28:31]
    s_add_u32 m0, s53, 129024
    s_add_u32 s52, s50, 3670016
    buffer_load_dwordx4 v15, s[20:23], s52 offen  lds
    v_mfma_f32_16x16x32_bf16 a[32:35], v[128:131], v[192:195], a[32:35]
    ds_read_b64_tr_b16 v[106:107], v248 offset:4416
    v_mfma_f32_16x16x32_bf16 a[36:39], v[132:135], v[192:195], a[36:39]
    ds_read_b64_tr_b16 v[108:109], v248 offset:72
    v_mfma_f32_16x16x32_bf16 a[40:43], v[136:139], v[192:195], a[40:43]
    s_add_u32 m0, s53, 130112
    s_add_u32 s52, s50, 3678208
    buffer_load_dwordx4 v15, s[20:23], s52 offen  lds
    v_mfma_f32_16x16x32_bf16 a[44:47], v[140:143], v[192:195], a[44:47]
    ds_read_b64_tr_b16 v[110:111], v248 offset:4424
    v_mfma_f32_16x16x32_bf16 a[48:51], v[144:147], v[192:195], a[48:51]
    v_mfma_f32_16x16x32_bf16 a[52:55], v[148:151], v[192:195], a[52:55]
    ds_read_b128 v[164:167], v240 offset:2048
    v_mfma_f32_16x16x32_bf16 a[56:59], v[152:155], v[192:195], a[56:59]
    ds_read_b64_tr_b16 v[112:113], v248 offset:128
    v_mfma_f32_16x16x32_bf16 a[60:63], v[156:159], v[192:195], a[60:63]
    s_add_u32 m0, s53, 131200
    s_add_u32 s52, s50, 3686400
    buffer_load_dwordx4 v15, s[20:23], s52 offen  lds
    v_mfma_f32_16x16x32_bf16 a[64:67], v[128:131], v[196:199], a[64:67]
    ds_read_b64_tr_b16 v[114:115], v248 offset:4480
    v_mfma_f32_16x16x32_bf16 a[68:71], v[132:135], v[196:199], a[68:71]
    ds_read_b64_tr_b16 v[116:117], v248 offset:136
    v_mfma_f32_16x16x32_bf16 a[72:75], v[136:139], v[196:199], a[72:75]
    v_mfma_f32_16x16x32_bf16 a[76:79], v[140:143], v[196:199], a[76:79]
    ds_read_b64_tr_b16 v[118:119], v248 offset:4488
    v_mfma_f32_16x16x32_bf16 a[80:83], v[144:147], v[196:199], a[80:83]
    ds_read_b64_tr_b16 v[120:121], v248 offset:192
    v_mfma_f32_16x16x32_bf16 a[84:87], v[148:151], v[196:199], a[84:87]
    s_add_u32 m0, s53, 132288
    s_add_u32 s52, s50, 3694592
    buffer_load_dwordx4 v15, s[20:23], s52 offen  lds
    v_mfma_f32_16x16x32_bf16 a[88:91], v[152:155], v[196:199], a[88:91]
    ds_read_b64_tr_b16 v[122:123], v248 offset:4544
    v_mfma_f32_16x16x32_bf16 a[92:95], v[156:159], v[196:199], a[92:95]
    s_add_u32 m0, s53, 133376
    s_add_u32 s52, s50, 3702784
    buffer_load_dwordx4 v15, s[20:23], s52 offen  lds
    v_mfma_f32_16x16x32_bf16 a[96:99], v[128:131], v[200:203], a[96:99]
    ds_read_b64_tr_b16 v[124:125], v248 offset:200
    v_mfma_f32_16x16x32_bf16 a[100:103], v[132:135], v[200:203], a[100:103]
    ds_read_b64_tr_b16 v[126:127], v248 offset:4552
    v_mfma_f32_16x16x32_bf16 a[104:107], v[136:139], v[200:203], a[104:107]
    v_mfma_f32_16x16x32_bf16 a[108:111], v[140:143], v[200:203], a[108:111]
    ds_read_b128 v[168:171], v240 offset:4096
    v_mfma_f32_16x16x32_bf16 a[112:115], v[144:147], v[200:203], a[112:115]
    ds_read_b128 v[172:175], v240 offset:6144
    v_mfma_f32_16x16x32_bf16 a[116:119], v[148:151], v[200:203], a[116:119]
    s_add_u32 m0, s53, 134464
    s_add_u32 s52, s50, 3710976
    buffer_load_dwordx4 v15, s[20:23], s52 offen  lds
    v_mfma_f32_16x16x32_bf16 a[120:123], v[152:155], v[200:203], a[120:123]
    ds_read_b128 v[176:179], v240 offset:8192
    v_mfma_f32_16x16x32_bf16 a[124:127], v[156:159], v[200:203], a[124:127]
    ds_read_b128 v[180:183], v240 offset:10240
    v_mfma_f32_16x16x32_bf16 a[128:131], v[128:131], v[204:207], a[128:131]
    s_add_u32 m0, s53, 135552
    s_add_u32 s52, s50, 3719168
    buffer_load_dwordx4 v15, s[20:23], s52 offen  lds
    v_mfma_f32_16x16x32_bf16 a[132:135], v[132:135], v[204:207], a[132:135]
    ds_read_b128 v[184:187], v244
    v_mfma_f32_16x16x32_bf16 a[136:139], v[136:139], v[204:207], a[136:139]
    v_mfma_f32_16x16x32_bf16 a[140:143], v[140:143], v[204:207], a[140:143]
    v_mfma_f32_16x16x32_bf16 a[144:147], v[144:147], v[204:207], a[144:147]
    v_mfma_f32_16x16x32_bf16 a[148:151], v[148:151], v[204:207], a[148:151]
    s_add_u32 m0, s53, 136640
    s_add_u32 s52, s50, 3727360
    buffer_load_dwordx4 v15, s[20:23], s52 offen  lds
    v_mfma_f32_16x16x32_bf16 a[152:155], v[152:155], v[204:207], a[152:155]
    v_mfma_f32_16x16x32_bf16 a[156:159], v[156:159], v[204:207], a[156:159]
    v_mfma_f32_16x16x32_bf16 a[160:163], v[128:131], v[208:211], a[160:163]
    v_mfma_f32_16x16x32_bf16 a[164:167], v[132:135], v[208:211], a[164:167]
    s_add_u32 m0, s49, 102400
    s_add_u32 s52, s48, 896
    buffer_load_dwordx4 v250, s[16:19], s52 offen  lds
    v_mfma_f32_16x16x32_bf16 a[168:171], v[136:139], v[208:211], a[168:171]
    v_mfma_f32_16x16x32_bf16 a[172:175], v[140:143], v[208:211], a[172:175]
    v_mfma_f32_16x16x32_bf16 a[176:179], v[144:147], v[208:211], a[176:179]
    v_mfma_f32_16x16x32_bf16 a[180:183], v[148:151], v[208:211], a[180:183]
    v_mfma_f32_16x16x32_bf16 a[184:187], v[152:155], v[208:211], a[184:187]
    v_mfma_f32_16x16x32_bf16 a[188:191], v[156:159], v[208:211], a[188:191]
    s_cmp_eq_u32 s5, 0
    s_cbranch_scc0 L_q1_20
    v_mfma_f32_16x16x32_bf16 a[192:195], v[128:131], v[212:215], a[192:195]
    v_mfma_f32_16x16x32_bf16 a[196:199], v[132:135], v[212:215], a[196:199]
    v_mfma_f32_16x16x32_bf16 a[200:203], v[136:139], v[212:215], a[200:203]
    v_mfma_f32_16x16x32_bf16 a[204:207], v[140:143], v[212:215], a[204:207]
    s_branch L_q2_20
L_q1_20:
    v_mfma_f32_16x16x32_bf16 a[192:195], v[144:147], v[212:215], a[192:195]
    v_mfma_f32_16x16x32_bf16 a[196:199], v[148:151], v[212:215], a[196:199]
    v_mfma_f32_16x16x32_bf16 a[200:203], v[152:155], v[212:215], a[200:203]
    v_mfma_f32_16x16x32_bf16 a[204:207], v[156:159], v[212:215], a[204:207]
L_q2_20:
    s_waitcnt lgkmcnt(5)
    v_mfma_f32_16x16x32_bf16 a[0:3], v[96:99], v[160:163], a[0:3]
    ds_read_b128 v[188:191], v241 offset:0
    v_mfma_f32_16x16x32_bf16 a[4:7], v[100:103], v[160:163], a[4:7]
    ds_read_b64_tr_b16 v[128:129], v248 offset:8704
    s_add_u32 m0, s49, 103424
    s_add_u32 s52, s48, 11136
    buffer_load_dwordx4 v250, s[16:19], s52 offen  lds
    v_mfma_f32_16x16x32_bf16 a[8:11], v[104:107], v[160:163], a[8:11]
    ds_read_b64_tr_b16 v[130:131], v248 offset:13056
    v_mfma_f32_16x16x32_bf16 a[12:15], v[108:111], v[160:163], a[12:15]
    ds_read_b64_tr_b16 v[132:133], v248 offset:8712
    v_mfma_f32_16x16x32_bf16 a[16:19], v[112:115], v[160:163], a[16:19]
    v_mfma_f32_16x16x32_bf16 a[20:23], v[116:119], v[160:163], a[20:23]
    ds_read_b64_tr_b16 v[134:135], v248 offset:13064
    v_mfma_f32_16x16x32_bf16 a[24:27], v[120:123], v[160:163], a[24:27]
    ds_read_b64_tr_b16 v[136:137], v248 offset:8768
    v_mfma_f32_16x16x32_bf16 a[28:31], v[124:127], v[160:163], a[28:31]
    s_add_u32 m0, s49, 104448
    s_add_u32 s52, s48, 21376
    buffer_load_dwordx4 v250, s[16:19], s52 offen  lds
    v_mfma_f32_16x16x32_bf16 a[32:35], v[96:99], v[164:167], a[32:35]
    ds_read_b64_tr_b16 v[138:139], v248 offset:13120
    v_mfma_f32_16x16x32_bf16 a[36:39], v[100:103], v[164:167], a[36:39]
    ds_read_b64_tr_b16 v[140:141], v248 offset:8776
    v_mfma_f32_16x16x32_bf16 a[40:43], v[104:107], v[164:167], a[40:43]
    v_mfma_f32_16x16x32_bf16 a[44:47], v[108:111], v[164:167], a[44:47]
    ds_read_b64_tr_b16 v[142:143], v248 offset:13128
    v_mfma_f32_16x16x32_bf16 a[48:51], v[112:115], v[164:167], a[48:51]
    s_add_u32 m0, s49, 105472
    s_add_u32 s52, s48, 31616
    buffer_load_dwordx4 v250, s[16:19], s52 offen  lds
    v_mfma_f32_16x16x32_bf16 a[52:55], v[116:119], v[164:167], a[52:55]
    ds_read_b128 v[192:195], v241 offset:2048
    v_mfma_f32_16x16x32_bf16 a[56:59], v[120:123], v[164:167], a[56:59]
    ds_read_b64_tr_b16 v[144:145], v248 offset:8832
    v_mfma_f32_16x16x32_bf16 a[60:63], v[124:127], v[164:167], a[60:63]
    s_waitcnt lgkmcnt(14)
    v_mfma_f32_16x16x32_bf16 a[64:67], v[96:99], v[168:171], a[64:67]
    ds_read_b64_tr_b16 v[146:147], v248 offset:13184
    v_mfma_f32_16x16x32_bf16 a[68:71], v[100:103], v[168:171], a[68:71]
    ds_read_b64_tr_b16 v[148:149], v248 offset:8840
    v_mfma_f32_16x16x32_bf16 a[72:75], v[104:107], v[168:171], a[72:75]
    s_add_u32 m0, s49, 106496
    s_add_u32 s52, s48, 41856
    buffer_load_dwordx4 v250, s[16:19], s52 offen  lds
    v_mfma_f32_16x16x32_bf16 a[76:79], v[108:111], v[168:171], a[76:79]
    ds_read_b64_tr_b16 v[150:151], v248 offset:13192
    v_mfma_f32_16x16x32_bf16 a[80:83], v[112:115], v[168:171], a[80:83]
    ds_read_b64_tr_b16 v[152:153], v248 offset:8896
    v_mfma_f32_16x16x32_bf16 a[84:87], v[116:119], v[168:171], a[84:87]
    v_mfma_f32_16x16x32_bf16 a[88:91], v[120:123], v[168:171], a[88:91]
    ds_read_b64_tr_b16 v[154:155], v248 offset:13248
    v_mfma_f32_16x16x32_bf16 a[92:95], v[124:127], v[168:171], a[92:95]
    v_mfma_f32_16x16x32_bf16 a[96:99], v[96:99], v[172:175], a[96:99]
    ds_read_b64_tr_b16 v[156:157], v248 offset:8904
    v_mfma_f32_16x16x32_bf16 a[100:103], v[100:103], v[172:175], a[100:103]
    ds_read_b64_tr_b16 v[158:159], v248 offset:13256
    v_mfma_f32_16x16x32_bf16 a[104:107], v[104:107], v[172:175], a[104:107]
    v_mfma_f32_16x16x32_bf16 a[108:111], v[108:111], v[172:175], a[108:111]
    ds_read_b128 v[196:199], v241 offset:4096
    v_mfma_f32_16x16x32_bf16 a[112:115], v[112:115], v[172:175], a[112:115]
    ds_read_b128 v[200:203], v241 offset:6144
    v_mfma_f32_16x16x32_bf16 a[116:119], v[116:119], v[172:175], a[116:119]
    v_mfma_f32_16x16x32_bf16 a[120:123], v[120:123], v[172:175], a[120:123]
    ds_read_b128 v[204:207], v241 offset:8192
    v_mfma_f32_16x16x32_bf16 a[124:127], v[124:127], v[172:175], a[124:127]
    ds_read_b128 v[208:211], v241 offset:10240
    s_waitcnt lgkmcnt(15)
    v_mfma_f32_16x16x32_bf16 a[128:131], v[96:99], v[176:179], a[128:131]
    v_mfma_f32_16x16x32_bf16 a[132:135], v[100:103], v[176:179], a[132:135]
    ds_read_b128 v[212:215], v245
    v_mfma_f32_16x16x32_bf16 a[136:139], v[104:107], v[176:179], a[136:139]
    v_mfma_f32_16x16x32_bf16 a[140:143], v[108:111], v[176:179], a[140:143]
    v_mfma_f32_16x16x32_bf16 a[144:147], v[112:115], v[176:179], a[144:147]
    v_mfma_f32_16x16x32_bf16 a[148:151], v[116:119], v[176:179], a[148:151]
    v_mfma_f32_16x16x32_bf16 a[152:155], v[120:123], v[176:179], a[152:155]
    v_mfma_f32_16x16x32_bf16 a[156:159], v[124:127], v[176:179], a[156:159]
    v_mfma_f32_16x16x32_bf16 a[160:163], v[96:99], v[180:183], a[160:163]
    v_mfma_f32_16x16x32_bf16 a[164:167], v[100:103], v[180:183], a[164:167]
    v_mfma_f32_16x16x32_bf16 a[168:171], v[104:107], v[180:183], a[168:171]
    v_mfma_f32_16x16x32_bf16 a[172:175], v[108:111], v[180:183], a[172:175]
    v_mfma_f32_16x16x32_bf16 a[176:179], v[112:115], v[180:183], a[176:179]
    v_mfma_f32_16x16x32_bf16 a[180:183], v[116:119], v[180:183], a[180:183]
    v_mfma_f32_16x16x32_bf16 a[184:187], v[120:123], v[180:183], a[184:187]
    v_mfma_f32_16x16x32_bf16 a[188:191], v[124:127], v[180:183], a[188:191]
    s_cmp_eq_u32 s5, 0
    s_cbranch_scc0 L_q1_21
    v_mfma_f32_16x16x32_bf16 a[192:195], v[96:99], v[184:187], a[192:195]
    v_mfma_f32_16x16x32_bf16 a[196:199], v[100:103], v[184:187], a[196:199]
    v_mfma_f32_16x16x32_bf16 a[200:203], v[104:107], v[184:187], a[200:203]
    v_mfma_f32_16x16x32_bf16 a[204:207], v[108:111], v[184:187], a[204:207]
    s_branch L_q2_21
L_q1_21:
    v_mfma_f32_16x16x32_bf16 a[192:195], v[112:115], v[184:187], a[192:195]
    v_mfma_f32_16x16x32_bf16 a[196:199], v[116:119], v[184:187], a[196:199]
    v_mfma_f32_16x16x32_bf16 a[200:203], v[120:123], v[184:187], a[200:203]
    v_mfma_f32_16x16x32_bf16 a[204:207], v[124:127], v[184:187], a[204:207]
L_q2_21:
    s_waitcnt vmcnt(0) lgkmcnt(0)
    s_barrier
    v_mfma_f32_16x16x32_bf16 a[0:3], v[128:131], v[188:191], a[0:3]
    ds_read_b128 v[160:163], v242 offset:0
    v_mfma_f32_16x16x32_bf16 a[4:7], v[132:135], v[188:191], a[4:7]
    ds_read_b64_tr_b16 v[96:97], v249 offset:0
    v_mfma_f32_16x16x32_bf16 a[8:11], v[136:139], v[188:191], a[8:11]
    ds_read_b64_tr_b16 v[98:99], v249 offset:4352
    s_cmp_eq_u32 s3, 3
    s_cbranch_scc1 L_xs22
    s_add_u32 m0, s49, 46080
    s_add_u32 s52, s48, 52224
    buffer_load_dwordx4 v250, s[16:19], s52 offen  lds
    s_add_u32 m0, s49, 47104
    s_add_u32 s52, s48, 62464
    buffer_load_dwordx4 v250, s[16:19], s52 offen  lds
L_xs22:
    v_mfma_f32_16x16x32_bf16 a[12:15], v[140:143], v[188:191], a[12:15]
    ds_read_b64_tr_b16 v[100:101], v249 offset:8
    v_mfma_f32_16x16x32_bf16 a[16:19], v[144:147], v[188:191], a[16:19]
    v_mfma_f32_16x16x32_bf16 a[20:23], v[148:151], v[188:191], a[20:23]
    ds_read_b64_tr_b16 v[102:103], v249 offset:4360
    v_mfma_f32_16x16x32_bf16 a[24:27], v[152:155], v[188:191], a[24:27]
    ds_read_b64_tr_b16 v[104:105], v249 offset:64
    v_mfma_f32_16x16x32_bf16 a[28:31], v[156:159], v[188:191], a[28:31]
    s_add_u32 m0, s53, 67584
    s_add_u32 s52, s50, 4194304
    buffer_load_dwordx4 v15, s[20:23], s52 offen  lds
    v_mfma_f32_16x16x32_bf16 a[32:35], v[128:131], v[192:195], a[32:35]
    ds_read_b64_tr_b16 v[106:107], v249 offset:4416
    v_mfma_f32_16x16x32_bf16 a[36:39], v[132:135], v[192:195], a[36:39]
    ds_read_b64_tr_b16 v[108:109], v249 offset:72
    v_mfma_f32_16x16x32_bf16 a[40:43], v[136:139], v[192:195], a[40:43]
    s_add_u32 m0, s53, 68672
    s_add_u32 s52, s50, 4202496
    buffer_load_dwordx4 v15, s[20:23], s52 offen  lds
    v_mfma_f32_16x16x32_bf16 a[44:47], v[140:143], v[192:195], a[44:47]
    ds_read_b64_tr_b16 v[110:111], v249 offset:4424
    v_mfma_f32_16x16x32_bf16 a[48:51], v[144:147], v[192:195], a[48:51]
    v_mfma_f32_16x16x32_bf16 a[52:55], v[148:151], v[192:195], a[52:55]
    ds_read_b128 v[164:167], v242 offset:2048
    v_mfma_f32_16x16x32_bf16 a[56:59], v[152:155], v[192:195], a[56:59]
    ds_read_b64_tr_b16 v[112:113], v249 offset:128
    v_mfma_f32_16x16x32_bf16 a[60:63], v[156:159], v[192:195], a[60:63]
    s_add_u32 m0, s53, 69760
    s_add_u32 s52, s50, 4210688
    buffer_load_dwordx4 v15, s[20:23], s52 offen  lds
    v_mfma_f32_16x16x32_bf16 a[64:67], v[128:131], v[196:199], a[64:67]
    ds_read_b64_tr_b16 v[114:115], v249 offset:4480
    v_mfma_f32_16x16x32_bf16 a[68:71], v[132:135], v[196:199], a[68:71]
    ds_read_b64_tr_b16 v[116:117], v249 offset:136
    v_mfma_f32_16x16x32_bf16 a[72:75], v[136:139], v[196:199], a[72:75]
    v_mfma_f32_16x16x32_bf16 a[76:79], v[140:143], v[196:199], a[76:79]
    ds_read_b64_tr_b16 v[118:119], v249 offset:4488
    v_mfma_f32_16x16x32_bf16 a[80:83], v[144:147], v[196:199], a[80:83]
    ds_read_b64_tr_b16 v[120:121], v249 offset:192
    v_mfma_f32_16x16x32_bf16 a[84:87], v[148:151], v[196:199], a[84:87]
    s_add_u32 m0, s53, 70848
    s_add_u32 s52, s50, 4218880
    buffer_load_dwordx4 v15, s[20:23], s52 offen  lds
    v_mfma_f32_16x16x32_bf16 a[88:91], v[152:155], v[196:199], a[88:91]
    ds_read_b64_tr_b16 v[122:123], v249 offset:4544
    v_mfma_f32_16x16x32_bf16 a[92:95], v[156:159], v[196:199], a[92:95]
    s_add_u32 m0, s53, 71936
    s_add_u32 s52, s50, 4227072
    buffer_load_dwordx4 v15, s[20:23], s52 offen  lds
    v_mfma_f32_16x16x32_bf16 a[96:99], v[128:131], v[200:203], a[96:99]
    ds_read_b64_tr_b16 v[124:125], v249 offset:200
    v_mfma_f32_16x16x32_bf16 a[100:103], v[132:135], v[200:203], a[100:103]
    ds_read_b64_tr_b16 v[126:127], v249 offset:4552
    v_mfma_f32_16x16x32_bf16 a[104:107], v[136:139], v[200:203], a[104:107]
    v_mfma_f32_16x16x32_bf16 a[108:111], v[140:143], v[200:203], a[108:111]
    ds_read_b128 v[168:171], v242 offset:4096
    v_mfma_f32_16x16x32_bf16 a[112:115], v[144:147], v[200:203], a[112:115]
    ds_read_b128 v[172:175], v242 offset:6144
    v_mfma_f32_16x16x32_bf16 a[116:119], v[148:151], v[200:203], a[116:119]
    s_add_u32 m0, s53, 73024
    s_add_u32 s52, s50, 4235264
    buffer_load_dwordx4 v15, s[20:23], s52 offen  lds
    v_mfma_f32_16x16x32_bf16 a[120:123], v[152:155], v[200:203], a[120:123]
    ds_read_b128 v[176:179], v242 offset:8192
    v_mfma_f32_16x16x32_bf16 a[124:127], v[156:159], v[200:203], a[124:127]
    ds_read_b128 v[180:183], v242 offset:10240
    v_mfma_f32_16x16x32_bf16 a[128:131], v[128:131], v[204:207], a[128:131]
    s_add_u32 m0, s53, 74112
    s_add_u32 s52, s50, 4243456
    buffer_load_dwordx4 v15, s[20:23], s52 offen  lds
    v_mfma_f32_16x16x32_bf16 a[132:135], v[132:135], v[204:207], a[132:135]
    ds_read_b128 v[184:187], v246
    v_mfma_f32_16x16x32_bf16 a[136:139], v[136:139], v[204:207], a[136:139]
    v_mfma_f32_16x16x32_bf16 a[140:143], v[140:143], v[204:207], a[140:143]
    v_mfma_f32_16x16x32_bf16 a[144:147], v[144:147], v[204:207], a[144:147]
    v_mfma_f32_16x16x32_bf16 a[148:151], v[148:151], v[204:207], a[148:151]
    s_add_u32 m0, s53, 75200
    s_add_u32 s52, s50, 4251648
    buffer_load_dwordx4 v15, s[20:23], s52 offen  lds
    v_mfma_f32_16x16x32_bf16 a[152:155], v[152:155], v[204:207], a[152:155]
    v_mfma_f32_16x16x32_bf16 a[156:159], v[156:159], v[204:207], a[156:159]
    v_mfma_f32_16x16x32_bf16 a[160:163], v[128:131], v[208:211], a[160:163]
    v_mfma_f32_16x16x32_bf16 a[164:167], v[132:135], v[208:211], a[164:167]
    s_add_u32 m0, s49, 40960
    s_add_u32 s52, s48, 1024
    buffer_load_dwordx4 v250, s[16:19], s52 offen  lds
    v_mfma_f32_16x16x32_bf16 a[168:171], v[136:139], v[208:211], a[168:171]
    v_mfma_f32_16x16x32_bf16 a[172:175], v[140:143], v[208:211], a[172:175]
    v_mfma_f32_16x16x32_bf16 a[176:179], v[144:147], v[208:211], a[176:179]
    v_mfma_f32_16x16x32_bf16 a[180:183], v[148:151], v[208:211], a[180:183]
    v_mfma_f32_16x16x32_bf16 a[184:187], v[152:155], v[208:211], a[184:187]
    v_mfma_f32_16x16x32_bf16 a[188:191], v[156:159], v[208:211], a[188:191]
    s_cmp_eq_u32 s5, 0
    s_cbranch_scc0 L_q1_23
    v_mfma_f32_16x16x32_bf16 a[192:195], v[128:131], v[212:215], a[192:195]
    v_mfma_f32_16x16x32_bf16 a[196:199], v[132:135], v[212:215], a[196:199]
    v_mfma_f32_16x16x32_bf16 a[200:203], v[136:139], v[212:215], a[200:203]
    v_mfma_f32_16x16x32_bf16 a[204:207], v[140:143], v[212:215], a[204:207]
    s_branch L_q2_23
L_q1_23:
    v_mfma_f32_16x16x32_bf16 a[192:195], v[144:147], v[212:215], a[192:195]
    v_mfma_f32_16x16x32_bf16 a[196:199], v[148:151], v[212:215], a[196:199]
    v_mfma_f32_16x16x32_bf16 a[200:203], v[152:155], v[212:215], a[200:203]
    v_mfma_f32_16x16x32_bf16 a[204:207], v[156:159], v[212:215], a[204:207]
L_q2_23:
    s_waitcnt lgkmcnt(5)
    v_mfma_f32_16x16x32_bf16 a[0:3], v[96:99], v[160:163], a[0:3]
    ds_read_b128 v[188:191], v243 offset:0
    v_mfma_f32_16x16x32_bf16 a[4:7], v[100:103], v[160:163], a[4:7]
    ds_read_b64_tr_b16 v[128:129], v249 offset:8704
    s_add_u32 m0, s49, 41984
    s_add_u32 s52, s48, 11264
    buffer_load_dwordx4 v250, s[16:19], s52 offen  lds
    v_mfma_f32_16x16x32_bf16 a[8:11], v[104:107], v[160:163], a[8:11]
    ds_read_b64_tr_b16 v[130:131], v249 offset:13056
    v_mfma_f32_16x16x32_bf16 a[12:15], v[108:111], v[160:163], a[12:15]
    ds_read_b64_tr_b16 v[132:133], v249 offset:8712
    v_mfma_f32_16x16x32_bf16 a[16:19], v[112:115], v[160:163], a[16:19]
    v_mfma_f32_16x16x32_bf16 a[20:23], v[116:119], v[160:163], a[20:23]
    ds_read_b64_tr_b16 v[134:135], v249 offset:13064
    v_mfma_f32_16x16x32_bf16 a[24:27], v[120:123], v[160:163], a[24:27]
    ds_read_b64_tr_b16 v[136:137], v249 offset:8768
    v_mfma_f32_16x16x32_bf16 a[28:31], v[124:127], v[160:163], a[28:31]
    s_add_u32 m0, s49, 43008
    s_add_u32 s52, s48, 21504
    buffer_load_dwordx4 v250, s[16:19], s52 offen  lds
    v_mfma_f32_16x16x32_bf16 a[32:35], v[96:99], v[164:167], a[32:35]
    ds_read_b64_tr_b16 v[138:139], v249 offset:13120
    v_mfma_f32_16x16x32_bf16 a[36:39], v[100:103], v[164:167], a[36:39]
    ds_read_b64_tr_b16 v[140:141], v249 offset:8776
    v_mfma_f32_16x16x32_bf16 a[40:43], v[104:107], v[164:167], a[40:43]
    v_mfma_f32_16x16x32_bf16 a[44:47], v[108:111], v[164:167], a[44:47]
    ds_read_b64_tr_b16 v[142:143], v249 offset:13128
    v_mfma_f32_16x16x32_bf16 a[48:51], v[112:115], v[164:167], a[48:51]
    s_add_u32 m0, s49, 44032
    s_add_u32 s52, s48, 31744
    buffer_load_dwordx4 v250, s[16:19], s52 offen  lds
    v_mfma_f32_16x16x32_bf16 a[52:55], v[116:119], v[164:167], a[52:55]
    ds_read_b128 v[192:195], v243 offset:2048
    v_mfma_f32_16x16x32_bf16 a[56:59], v[120:123], v[164:167], a[56:59]
    ds_read_b64_tr_b16 v[144:145], v249 offset:8832
    v_mfma_f32_16x16x32_bf16 a[60:63], v[124:127], v[164:167], a[60:63]
    s_waitcnt lgkmcnt(14)
    v_mfma_f32_16x16x32_bf16 a[64:67], v[96:99], v[168:171], a[64:67]
    ds_read_b64_tr_b16 v[146:147], v249 offset:13184
    v_mfma_f32_16x16x32_bf16 a[68:71], v[100:103], v[168:171], a[68:71]
    ds_read_b64_tr_b16 v[148:149], v249 offset:8840
    v_mfma_f32_16x16x32_bf16 a[72:75], v[104:107], v[168:171], a[72:75]
    s_add_u32 m0, s49, 45056
    s_add_u32 s52, s48, 41984
    buffer_load_dwordx4 v250, s[16:19], s52 offen  lds
    v_mfma_f32_16x16x32_bf16 a[76:79], v[108:111], v[168:171], a[76:79]
    ds_read_b64_tr_b16 v[150:151], v249 offset:13192
    v_mfma_f32_16x16x32_bf16 a[80:83], v[112:115], v[168:171], a[80:83]
    ds_read_b64_tr_b16 v[152:153], v249 offset:8896
    v_mfma_f32_16x16x32_bf16 a[84:87], v[116:119], v[168:171], a[84:87]
    v_mfma_f32_16x16x32_bf16 a[88:91], v[120:123], v[168:171], a[88:91]
    ds_read_b64_tr_b16 v[154:155], v249 offset:13248
    v_mfma_f32_16x16x32_bf16 a[92:95], v[124:127], v[168:171], a[92:95]
    v_mfma_f32_16x16x32_bf16 a[96:99], v[96:99], v[172:175], a[96:99]
    ds_read_b64_tr_b16 v[156:157], v249 offset:8904
    v_mfma_f32_16x16x32_bf16 a[100:103], v[100:103], v[172:175], a[100:103]
    ds_read_b64_tr_b16 v[158:159], v249 offset:13256
    v_mfma_f32_16x16x32_bf16 a[104:107], v[104:107], v[172:175], a[104:107]
    v_mfma_f32_16x16x32_bf16 a[108:111], v[108:111], v[172:175], a[108:111]
    ds_read_b128 v[196:199], v243 offset:4096
    v_mfma_f32_16x16x32_bf16 a[112:115], v[112:115], v[172:175], a[112:115]
    ds_read_b128 v[200:203], v243 offset:6144
    v_mfma_f32_16x16x32_bf16 a[116:119], v[116:119], v[172:175], a[116:119]
    v_mfma_f32_16x16x32_bf16 a[120:123], v[120:123], v[172:175], a[120:123]
    ds_read_b128 v[204:207], v243 offset:8192
    v_mfma_f32_16x16x32_bf16 a[124:127], v[124:127], v[172:175], a[124:127]
    ds_read_b128 v[208:211], v243 offset:10240
    s_waitcnt lgkmcnt(15)
    v_mfma_f32_16x16x32_bf16 a[128:131], v[96:99], v[176:179], a[128:131]
    v_mfma_f32_16x16x32_bf16 a[132:135], v[100:103], v[176:179], a[132:135]
    ds_read_b128 v[212:215], v247
    v_mfma_f32_16x16x32_bf16 a[136:139], v[104:107], v[176:179], a[136:139]
    v_mfma_f32_16x16x32_bf16 a[140:143], v[108:111], v[176:179], a[140:143]
    v_mfma_f32_16x16x32_bf16 a[144:147], v[112:115], v[176:179], a[144:147]
    v_mfma_f32_16x16x32_bf16 a[148:151], v[116:119], v[176:179], a[148:151]
    v_mfma_f32_16x16x32_bf16 a[152:155], v[120:123], v[176:179], a[152:155]
    v_mfma_f32_16x16x32_bf16 a[156:159], v[124:127], v[176:179], a[156:159]
    v_mfma_f32_16x16x32_bf16 a[160:163], v[96:99], v[180:183], a[160:163]
    v_mfma_f32_16x16x32_bf16 a[164:167], v[100:103], v[180:183], a[164:167]
    v_mfma_f32_16x16x32_bf16 a[168:171], v[104:107], v[180:183], a[168:171]
    v_mfma_f32_16x16x32_bf16 a[172:175], v[108:111], v[180:183], a[172:175]
    v_mfma_f32_16x16x32_bf16 a[176:179], v[112:115], v[180:183], a[176:179]
    v_mfma_f32_16x16x32_bf16 a[180:183], v[116:119], v[180:183], a[180:183]
    v_mfma_f32_16x16x32_bf16 a[184:187], v[120:123], v[180:183], a[184:187]
    v_mfma_f32_16x16x32_bf16 a[188:191], v[124:127], v[180:183], a[188:191]
    s_cmp_eq_u32 s5, 0
    s_cbranch_scc0 L_q1_24
    v_mfma_f32_16x16x32_bf16 a[192:195], v[96:99], v[184:187], a[192:195]
    v_mfma_f32_16x16x32_bf16 a[196:199], v[100:103], v[184:187], a[196:199]
    v_mfma_f32_16x16x32_bf16 a[200:203], v[104:107], v[184:187], a[200:203]
    v_mfma_f32_16x16x32_bf16 a[204:207], v[108:111], v[184:187], a[204:207]
    s_branch L_q2_24
L_q1_24:
    v_mfma_f32_16x16x32_bf16 a[192:195], v[112:115], v[184:187], a[192:195]
    v_mfma_f32_16x16x32_bf16 a[196:199], v[116:119], v[184:187], a[196:199]
    v_mfma_f32_16x16x32_bf16 a[200:203], v[120:123], v[184:187], a[200:203]
    v_mfma_f32_16x16x32_bf16 a[204:207], v[124:127], v[184:187], a[204:207]
L_q2_24:
    s_waitcnt vmcnt(0) lgkmcnt(0)
    s_barrier
    v_mfma_f32_16x16x32_bf16 a[0:3], v[128:131], v[188:191], a[0:3]
    ds_read_b128 v[160:163], v240 offset:0
    v_mfma_f32_16x16x32_bf16 a[4:7], v[132:135], v[188:191], a[4:7]
    ds_read_b64_tr_b16 v[96:97], v248 offset:0
    v_mfma_f32_16x16x32_bf16 a[8:11], v[136:139], v[188:191], a[8:11]
    ds_read_b64_tr_b16 v[98:99], v248 offset:4352
    s_cmp_eq_u32 s3, 3
    s_cbranch_scc1 L_xs25
    s_add_u32 m0, s49, 107520
    s_add_u32 s52, s48, 52352
    buffer_load_dwordx4 v250, s[16:19], s52 offen  lds
    s_add_u32 m0, s49, 108544
    s_add_u32 s52, s48, 62592
    buffer_load_dwordx4 v250, s[16:19], s52 offen  lds
L_xs25:
    v_mfma_f32_16x16x32_bf16 a[12:15], v[140:143], v[188:191], a[12:15]
    ds_read_b64_tr_b16 v[100:101], v248 offset:8
    v_mfma_f32_16x16x32_bf16 a[16:19], v[144:147], v[188:191], a[16:19]
    v_mfma_f32_16x16x32_bf16 a[20:23], v[148:151], v[188:191], a[20:23]
    ds_read_b64_tr_b16 v[102:103], v248 offset:4360
    v_mfma_f32_16x16x32_bf16 a[24:27], v[152:155], v[188:191], a[24:27]
    ds_read_b64_tr_b16 v[104:105], v248 offset:64
    v_mfma_f32_16x16x32_bf16 a[28:31], v[156:159], v[188:191], a[28:31]
    s_add_u32 m0, s53, 129024
    s_add_u32 s52, s50, 4718592
    buffer_load_dwordx4 v15, s[20:23], s52 offen  lds
    v_mfma_f32_16x16x32_bf16 a[32:35], v[128:131], v[192:195], a[32:35]
    ds_read_b64_tr_b16 v[106:107], v248 offset:4416
    v_mfma_f32_16x16x32_bf16 a[36:39], v[132:135], v[192:195], a[36:39]
    ds_read_b64_tr_b16 v[108:109], v248 offset:72
    v_mfma_f32_16x16x32_bf16 a[40:43], v[136:139], v[192:195], a[40:43]
    s_add_u32 m0, s53, 130112
    s_add_u32 s52, s50, 4726784
    buffer_load_dwordx4 v15, s[20:23], s52 offen  lds
    v_mfma_f32_16x16x32_bf16 a[44:47], v[140:143], v[192:195], a[44:47]
    ds_read_b64_tr_b16 v[110:111], v248 offset:4424
    v_mfma_f32_16x16x32_bf16 a[48:51], v[144:147], v[192:195], a[48:51]
    v_mfma_f32_16x16x32_bf16 a[52:55], v[148:151], v[192:195], a[52:55]
    ds_read_b128 v[164:167], v240 offset:2048
    v_mfma_f32_16x16x32_bf16 a[56:59], v[152:155], v[192:195], a[56:59]
    ds_read_b64_tr_b16 v[112:113], v248 offset:128
    v_mfma_f32_16x16x32_bf16 a[60:63], v[156:159], v[192:195], a[60:63]
    s_add_u32 m0, s53, 131200
    s_add_u32 s52, s50, 4734976
    buffer_load_dwordx4 v15, s[20:23], s52 offen  lds
    v_mfma_f32_16x16x32_bf16 a[64:67], v[128:131], v[196:199], a[64:67]
    ds_read_b64_tr_b16 v[114:115], v248 offset:4480
    v_mfma_f32_16x16x32_bf16 a[68:71], v[132:135], v[196:199], a[68:71]
    ds_read_b64_tr_b16 v[116:117], v248 offset:136
    v_mfma_f32_16x16x32_bf16 a[72:75], v[136:139], v[196:199], a[72:75]
    v_mfma_f32_16x16x32_bf16 a[76:79], v[140:143], v[196:199], a[76:79]
    ds_read_b64_tr_b16 v[118:119], v248 offset:4488
    v_mfma_f32_16x16x32_bf16 a[80:83], v[144:147], v[196:199], a[80:83]
    ds_read_b64_tr_b16 v[120:121], v248 offset:192
    v_mfma_f32_16x16x32_bf16 a[84:87], v[148:151], v[196:199], a[84:87]
    s_add_u32 m0, s53, 132288
    s_add_u32 s52, s50, 4743168
    buffer_load_dwordx4 v15, s[20:23], s52 offen  lds
    v_mfma_f32_16x16x32_bf16 a[88:91], v[152:155], v[196:199], a[88:91]
    ds_read_b64_tr_b16 v[122:123], v248 offset:4544
    v_mfma_f32_16x16x32_bf16 a[92:95], v[156:159], v[196:199], a[92:95]
    s_add_u32 m0, s53, 133376
    s_add_u32 s52, s50, 4751360
    buffer_load_dwordx4 v15, s[20:23], s52 offen  lds
    v_mfma_f32_16x16x32_bf16 a[96:99], v[128:131], v[200:203], a[96:99]
    ds_read_b64_tr_b16 v[124:125], v248 offset:200
    v_mfma_f32_16x16x32_bf16 a[100:103], v[132:135], v[200:203], a[100:103]
    ds_read_b64_tr_b16 v[126:127], v248 offset:4552
    v_mfma_f32_16x16x32_bf16 a[104:107], v[136:139], v[200:203], a[104:107]
    v_mfma_f32_16x16x32_bf16 a[108:111], v[140:143], v[200:203], a[108:111]
    ds_read_b128 v[168:171], v240 offset:4096
    v_mfma_f32_16x16x32_bf16 a[112:115], v[144:147], v[200:203], a[112:115]
    ds_read_b128 v[172:175], v240 offset:6144
    v_mfma_f32_16x16x32_bf16 a[116:119], v[148:151], v[200:203], a[116:119]
    s_add_u32 m0, s53, 134464
    s_add_u32 s52, s50, 4759552
    buffer_load_dwordx4 v15, s[20:23], s52 offen  lds
    v_mfma_f32_16x16x32_bf16 a[120:123], v[152:155], v[200:203], a[120:123]
    ds_read_b128 v[176:179], v240 offset:8192
    v_mfma_f32_16x16x32_bf16 a[124:127], v[156:159], v[200:203], a[124:127]
    ds_read_b128 v[180:183], v240 offset:10240
    v_mfma_f32_16x16x32_bf16 a[128:131], v[128:131], v[204:207], a[128:131]
    s_add_u32 m0, s53, 135552
    s_add_u32 s52, s50, 4767744
    buffer_load_dwordx4 v15, s[20:23], s52 offen  lds
    v_mfma_f32_16x16x32_bf16 a[132:135], v[132:135], v[204:207], a[132:135]
    ds_read_b128 v[184:187], v244
    v_mfma_f32_16x16x32_bf16 a[136:139], v[136:139], v[204:207], a[136:139]
    v_mfma_f32_16x16x32_bf16 a[140:143], v[140:143], v[204:207], a[140:143]
    v_mfma_f32_16x16x32_bf16 a[144:147], v[144:147], v[204:207], a[144:147]
    v_mfma_f32_16x16x32_bf16 a[148:151], v[148:151], v[204:207], a[148:151]
    s_add_u32 m0, s53, 136640
    s_add_u32 s52, s50, 4775936
    buffer_load_dwordx4 v15, s[20:23], s52 offen  lds
    v_mfma_f32_16x16x32_bf16 a[152:155], v[152:155], v[204:207], a[152:155]
    v_mfma_f32_16x16x32_bf16 a[156:159], v[156:159], v[204:207], a[156:159]
    v_mfma_f32_16x16x32_bf16 a[160:163], v[128:131], v[208:211], a[160:163]
    v_mfma_f32_16x16x32_bf16 a[164:167], v[132:135], v[208:211], a[164:167]
    s_add_u32 m0, s49, 102400
    s_add_u32 s52, s48, 1152
    buffer_load_dwordx4 v250, s[16:19], s52 offen  lds
    v_mfma_f32_16x16x32_bf16 a[168:171], v[136:139], v[208:211], a[168:171]
    v_mfma_f32_16x16x32_bf16 a[172:175], v[140:143], v[208:211], a[172:175]
    v_mfma_f32_16x16x32_bf16 a[176:179], v[144:147], v[208:211], a[176:179]
    v_mfma_f32_16x16x32_bf16 a[180:183], v[148:151], v[208:211], a[180:183]
    v_mfma_f32_16x16x32_bf16 a[184:187], v[152:155], v[208:211], a[184:187]
    v_mfma_f32_16x16x32_bf16 a[188:191], v[156:159], v[208:211], a[188:191]
    s_cmp_eq_u32 s5, 0
    s_cbranch_scc0 L_q1_26
    v_mfma_f32_16x16x32_bf16 a[192:195], v[128:131], v[212:215], a[192:195]
    v_mfma_f32_16x16x32_bf16 a[196:199], v[132:135], v[212:215], a[196:199]
    v_mfma_f32_16x16x32_bf16 a[200:203], v[136:139], v[212:215], a[200:203]
    v_mfma_f32_16x16x32_bf16 a[204:207], v[140:143], v[212:215], a[204:207]
    s_branch L_q2_26
L_q1_26:
    v_mfma_f32_16x16x32_bf16 a[192:195], v[144:147], v[212:215], a[192:195]
    v_mfma_f32_16x16x32_bf16 a[196:199], v[148:151], v[212:215], a[196:199]
    v_mfma_f32_16x16x32_bf16 a[200:203], v[152:155], v[212:215], a[200:203]
    v_mfma_f32_16x16x32_bf16 a[204:207], v[156:159], v[212:215], a[204:207]
L_q2_26:
    s_waitcnt lgkmcnt(5)
    v_mfma_f32_16x16x32_bf16 a[0:3], v[96:99], v[160:163], a[0:3]
    ds_read_b128 v[188:191], v241 offset:0
    v_mfma_f32_16x16x32_bf16 a[4:7], v[100:103], v[160:163], a[4:7]
    ds_read_b64_tr_b16 v[128:129], v248 offset:8704
    s_add_u32 m0, s49, 103424
    s_add_u32 s52, s48, 11392
    buffer_load_dwordx4 v250, s[16:19], s52 offen  lds
    v_mfma_f32_16x16x32_bf16 a[8:11], v[104:107], v[160:163], a[8:11]
    ds_read_b64_tr_b16 v[130:131], v248 offset:13056
    v_mfma_f32_16x16x32_bf16 a[12:15], v[108:111], v[160:163], a[12:15]
    ds_read_b64_tr_b16 v[132:133], v248 offset:8712
    v_mfma_f32_16x16x32_bf16 a[16:19], v[112:115], v[160:163], a[16:19]
    v_mfma_f32_16x16x32_bf16 a[20:23], v[116:119], v[160:163], a[20:23]
    ds_read_b64_tr_b16 v[134:135], v248 offset:13064
    v_mfma_f32_16x16x32_bf16 a[24:27], v[120:123], v[160:163], a[24:27]
    ds_read_b64_tr_b16 v[136:137], v248 offset:8768
    v_mfma_f32_16x16x32_bf16 a[28:31], v[124:127], v[160:163], a[28:31]
    s_add_u32 m0, s49, 104448
    s_add_u32 s52, s48, 21632
    buffer_load_dwordx4 v250, s[16:19], s52 offen  lds
    v_mfma_f32_16x16x32_bf16 a[32:35], v[96:99], v[164:167], a[32:35]
    ds_read_b64_tr_b16 v[138:139], v248 offset:13120
    v_mfma_f32_16x16x32_bf16 a[36:39], v[100:103], v[164:167], a[36:39]
    ds_read_b64_tr_b16 v[140:141], v248 offset:8776
    v_mfma_f32_16x16x32_bf16 a[40:43], v[104:107], v[164:167], a[40:43]
    v_mfma_f32_16x16x32_bf16 a[44:47], v[108:111], v[164:167], a[44:47]
    ds_read_b64_tr_b16 v[142:143], v248 offset:13128
    v_mfma_f32_16x16x32_bf16 a[48:51], v[112:115], v[164:167], a[48:51]
    s_add_u32 m0, s49, 105472
    s_add_u32 s52, s48, 31872
    buffer_load_dwordx4 v250, s[16:19], s52 offen  lds
    v_mfma_f32_16x16x32_bf16 a[52:55], v[116:119], v[164:167], a[52:55]
    ds_read_b128 v[192:195], v241 offset:2048
    v_mfma_f32_16x16x32_bf16 a[56:59], v[120:123], v[164:167], a[56:59]
    ds_read_b64_tr_b16 v[144:145], v248 offset:8832
    v_mfma_f32_16x16x32_bf16 a[60:63], v[124:127], v[164:167], a[60:63]
    s_waitcnt lgkmcnt(14)
    v_mfma_f32_16x16x32_bf16 a[64:67], v[96:99], v[168:171], a[64:67]
    ds_read_b64_tr_b16 v[146:147], v248 offset:13184
    v_mfma_f32_16x16x32_bf16 a[68:71], v[100:103], v[168:171], a[68:71]
    ds_read_b64_tr_b16 v[148:149], v248 offset:8840
    v_mfma_f32_16x16x32_bf16 a[72:75], v[104:107], v[168:171], a[72:75]
    s_add_u32 m0, s49, 106496
    s_add_u32 s52, s48, 42112
    buffer_load_dwordx4 v250, s[16:19], s52 offen  lds
    v_mfma_f32_16x16x32_bf16 a[76:79], v[108:111], v[168:171], a[76:79]
    ds_read_b64_tr_b16 v[150:151], v248 offset:13192
    v_mfma_f32_16x16x32_bf16 a[80:83], v[112:115], v[168:171], a[80:83]
    ds_read_b64_tr_b16 v[152:153], v248 offset:8896
    v_mfma_f32_16x16x32_bf16 a[84:87], v[116:119], v[168:171], a[84:87]
    v_mfma_f32_16x16x32_bf16 a[88:91], v[120:123], v[168:171], a[88:91]
    ds_read_b64_tr_b16 v[154:155], v248 offset:13248
    v_mfma_f32_16x16x32_bf16 a[92:95], v[124:127], v[168:171], a[92:95]
    v_mfma_f32_16x16x32_bf16 a[96:99], v[96:99], v[172:175], a[96:99]
    ds_read_b64_tr_b16 v[156:157], v248 offset:8904
    v_mfma_f32_16x16x32_bf16 a[100:103], v[100:103], v[172:175], a[100:103]
    ds_read_b64_tr_b16 v[158:159], v248 offset:13256
    v_mfma_f32_16x16x32_bf16 a[104:107], v[104:107], v[172:175], a[104:107]
    v_mfma_f32_16x16x32_bf16 a[108:111], v[108:111], v[172:175], a[108:111]
    ds_read_b128 v[196:199], v241 offset:4096
    v_mfma_f32_16x16x32_bf16 a[112:115], v[112:115], v[172:175], a[112:115]
    ds_read_b128 v[200:203], v241 offset:6144
    v_mfma_f32_16x16x32_bf16 a[116:119], v[116:119], v[172:175], a[116:119]
    v_mfma_f32_16x16x32_bf16 a[120:123], v[120:123], v[172:175], a[120:123]
    ds_read_b128 v[204:207], v241 offset:8192
    v_mfma_f32_16x16x32_bf16 a[124:127], v[124:127], v[172:175], a[124:127]
    ds_read_b128 v[208:211], v241 offset:10240
    s_waitcnt lgkmcnt(15)
    v_mfma_f32_16x16x32_bf16 a[128:131], v[96:99], v[176:179], a[128:131]
    v_mfma_f32_16x16x32_bf16 a[132:135], v[100:103], v[176:179], a[132:135]
    ds_read_b128 v[212:215], v245
    v_mfma_f32_16x16x32_bf16 a[136:139], v[104:107], v[176:179], a[136:139]
    v_mfma_f32_16x16x32_bf16 a[140:143], v[108:111], v[176:179], a[140:143]
    v_mfma_f32_16x16x32_bf16 a[144:147], v[112:115], v[176:179], a[144:147]
    v_mfma_f32_16x16x32_bf16 a[148:151], v[116:119], v[176:179], a[148:151]
    v_mfma_f32_16x16x32_bf16 a[152:155], v[120:123], v[176:179], a[152:155]
    v_mfma_f32_16x16x32_bf16 a[156:159], v[124:127], v[176:179], a[156:159]
    v_mfma_f32_16x16x32_bf16 a[160:163], v[96:99], v[180:183], a[160:163]
    v_mfma_f32_16x16x32_bf16 a[164:167], v[100:103], v[180:183], a[164:167]
    v_mfma_f32_16x16x32_bf16 a[168:171], v[104:107], v[180:183], a[168:171]
    v_mfma_f32_16x16x32_bf16 a[172:175], v[108:111], v[180:183], a[172:175]
    v_mfma_f32_16x16x32_bf16 a[176:179], v[112:115], v[180:183], a[176:179]
    v_mfma_f32_16x16x32_bf16 a[180:183], v[116:119], v[180:183], a[180:183]
    v_mfma_f32_16x16x32_bf16 a[184:187], v[120:123], v[180:183], a[184:187]
    v_mfma_f32_16x16x32_bf16 a[188:191], v[124:127], v[180:183], a[188:191]
    s_cmp_eq_u32 s5, 0
    s_cbranch_scc0 L_q1_27
    v_mfma_f32_16x16x32_bf16 a[192:195], v[96:99], v[184:187], a[192:195]
    v_mfma_f32_16x16x32_bf16 a[196:199], v[100:103], v[184:187], a[196:199]
    v_mfma_f32_16x16x32_bf16 a[200:203], v[104:107], v[184:187], a[200:203]
    v_mfma_f32_16x16x32_bf16 a[204:207], v[108:111], v[184:187], a[204:207]
    s_branch L_q2_27
L_q1_27:
    v_mfma_f32_16x16x32_bf16 a[192:195], v[112:115], v[184:187], a[192:195]
    v_mfma_f32_16x16x32_bf16 a[196:199], v[116:119], v[184:187], a[196:199]
    v_mfma_f32_16x16x32_bf16 a[200:203], v[120:123], v[184:187], a[200:203]
    v_mfma_f32_16x16x32_bf16 a[204:207], v[124:127], v[184:187], a[204:207]
L_q2_27:
    s_waitcnt vmcnt(0) lgkmcnt(0)
    s_barrier
    v_mfma_f32_16x16x32_bf16 a[0:3], v[128:131], v[188:191], a[0:3]
    ds_read_b128 v[160:163], v242 offset:0
    v_mfma_f32_16x16x32_bf16 a[4:7], v[132:135], v[188:191], a[4:7]
    ds_read_b64_tr_b16 v[96:97], v249 offset:0
    v_mfma_f32_16x16x32_bf16 a[8:11], v[136:139], v[188:191], a[8:11]
    ds_read_b64_tr_b16 v[98:99], v249 offset:4352
    s_add_u32 m0, s38, 0
    s_nop 0
    buffer_load_dwordx4 v6, s[12:15], s37 offen offset:0 nt lds
    v_mfma_f32_16x16x32_bf16 a[12:15], v[140:143], v[188:191], a[12:15]
    ds_read_b64_tr_b16 v[100:101], v249 offset:8
    v_mfma_f32_16x16x32_bf16 a[16:19], v[144:147], v[188:191], a[16:19]
    s_add_u32 m0, s38, 800
    s_nop 0
    buffer_load_dwordx4 v6, s[12:15], s37 offen offset:256 nt lds
    v_mfma_f32_16x16x32_bf16 a[20:23], v[148:151], v[188:191], a[20:23]
    ds_read_b64_tr_b16 v[102:103], v249 offset:4360
    v_mfma_f32_16x16x32_bf16 a[24:27], v[152:155], v[188:191], a[24:27]
    ds_read_b64_tr_b16 v[104:105], v249 offset:64
    v_mfma_f32_16x16x32_bf16 a[28:31], v[156:159], v[188:191], a[28:31]
    s_add_u32 m0, s38, 1600
    s_nop 0
    buffer_load_dwordx4 v6, s[12:15], s37 offen offset:512 nt lds
    v_mfma_f32_16x16x32_bf16 a[32:35], v[128:131], v[192:195], a[32:35]
    ds_read_b64_tr_b16 v[106:107], v249 offset:4416
    v_mfma_f32_16x16x32_bf16 a[36:39], v[132:135], v[192:195], a[36:39]
    ds_read_b64_tr_b16 v[108:109], v249 offset:72
    v_mfma_f32_16x16x32_bf16 a[40:43], v[136:139], v[192:195], a[40:43]
    s_add_u32 m0, s38, 2400
    s_nop 0
    buffer_load_dwordx4 v6, s[12:15], s37 offen offset:768 nt lds
    v_mfma_f32_16x16x32_bf16 a[44:47], v[140:143], v[192:195], a[44:47]
    ds_read_b64_tr_b16 v[110:111], v249 offset:4424
    v_mfma_f32_16x16x32_bf16 a[48:51], v[144:147], v[192:195], a[48:51]
    s_add_u32 m0, s38, 3200
    s_nop 0
    buffer_load_dwordx4 v6, s[12:15], s37 offen offset:1024 nt lds
    v_mfma_f32_16x16x32_bf16 a[52:55], v[148:151], v[192:195], a[52:55]
    ds_read_b128 v[164:167], v242 offset:2048
    v_mfma_f32_16x16x32_bf16 a[56:59], v[152:155], v[192:195], a[56:59]
    ds_read_b64_tr_b16 v[112:113], v249 offset:128
    v_mfma_f32_16x16x32_bf16 a[60:63], v[156:159], v[192:195], a[60:63]
    s_add_u32 m0, s38, 4000
    s_nop 0
    buffer_load_dwordx4 v6, s[12:15], s37 offen offset:1280 nt lds
    v_mfma_f32_16x16x32_bf16 a[64:67], v[128:131], v[196:199], a[64:67]
    ds_read_b64_tr_b16 v[114:115], v249 offset:4480
    v_mfma_f32_16x16x32_bf16 a[68:71], v[132:135], v[196:199], a[68:71]
    ds_read_b64_tr_b16 v[116:117], v249 offset:136
    v_mfma_f32_16x16x32_bf16 a[72:75], v[136:139], v[196:199], a[72:75]
    s_add_u32 m0, s38, 4800
    s_nop 0
    buffer_load_dwordx4 v6, s[12:15], s37 offen offset:1536 nt lds
    v_mfma_f32_16x16x32_bf16 a[76:79], v[140:143], v[196:199], a[76:79]
    ds_read_b64_tr_b16 v[118:119], v249 offset:4488
    s_add_u32 m0, s38, 5600
    s_nop 0
    buffer_load_dwordx4 v6, s[12:15], s37 offen offset:1792 nt lds
    v_mfma_f32_16x16x32_bf16 a[80:83], v[144:147], v[196:199], a[80:83]
    ds_read_b64_tr_b16 v[120:121], v249 offset:192
    v_mfma_f32_16x16x32_bf16 a[84:87], v[148:151], v[196:199], a[84:87]
    s_add_u32 s37, s37, 8192
        s_add_u32 s38, s38, 33792
        s_cmp_ge_u32 s38, s42
        s_cselect_b32 s38, s41, s38
    v_mfma_f32_16x16x32_bf16 a[88:91], v[152:155], v[196:199], a[88:91]
    ds_read_b64_tr_b16 v[122:123], v249 offset:4544
    v_mfma_f32_16x16x32_bf16 a[92:95], v[156:159], v[196:199], a[92:95]
    s_add_u32 m0, s38, 0
    s_nop 0
    buffer_load_dwordx4 v6, s[12:15], s37 offen offset:0 nt lds
    v_mfma_f32_16x16x32_bf16 a[96:99], v[128:131], v[200:203], a[96:99]
    ds_read_b64_tr_b16 v[124:125], v249 offset:200
    v_mfma_f32_16x16x32_bf16 a[100:103], v[132:135], v[200:203], a[100:103]
    ds_read_b64_tr_b16 v[126:127], v249 offset:4552
    v_mfma_f32_16x16x32_bf16 a[104:107], v[136:139], v[200:203], a[104:107]
    s_add_u32 m0, s38, 800
    s_nop 0
    buffer_load_dwordx4 v6, s[12:15], s37 offen offset:256 nt lds
    v_mfma_f32_16x16x32_bf16 a[108:111], v[140:143], v[200:203], a[108:111]
    ds_read_b128 v[168:171], v242 offset:4096
    v_mfma_f32_16x16x32_bf16 a[112:115], v[144:147], v[200:203], a[112:115]
    ds_read_b128 v[172:175], v242 offset:6144
    v_mfma_f32_16x16x32_bf16 a[116:119], v[148:151], v[200:203], a[116:119]
    s_add_u32 m0, s38, 1600
    s_nop 0
    buffer_load_dwordx4 v6, s[12:15], s37 offen offset:512 nt lds
    v_mfma_f32_16x16x32_bf16 a[120:123], v[152:155], v[200:203], a[120:123]
    ds_read_b128 v[176:179], v242 offset:8192
    v_mfma_f32_16x16x32_bf16 a[124:127], v[156:159], v[200:203], a[124:127]
    ds_read_b128 v[180:183], v242 offset:10240
    v_mfma_f32_16x16x32_bf16 a[128:131], v[128:131], v[204:207], a[128:131]
    s_add_u32 m0, s38, 2400
    s_nop 0
    buffer_load_dwordx4 v6, s[12:15], s37 offen offset:768 nt lds
    v_mfma_f32_16x16x32_bf16 a[132:135], v[132:135], v[204:207], a[132:135]
    ds_read_b128 v[184:187], v246
    v_mfma_f32_16x16x32_bf16 a[136:139], v[136:139], v[204:207], a[136:139]
    s_add_u32 m0, s38, 3200
    s_nop 0
    buffer_load_dwordx4 v6, s[12:15], s37 offen offset:1024 nt lds
    v_mfma_f32_16x16x32_bf16 a[140:143], v[140:143], v[204:207], a[140:143]
    v_mfma_f32_16x16x32_bf16 a[144:147], v[144:147], v[204:207], a[144:147]
    s_add_u32 m0, s38, 4000
    s_nop 0
    buffer_load_dwordx4 v6, s[12:15], s37 offen offset:1280 nt lds
    v_mfma_f32_16x16x32_bf16 a[148:151], v[148:151], v[204:207], a[148:151]
    v_mfma_f32_16x16x32_bf16 a[152:155], v[152:155], v[204:207], a[152:155]
    s_add_u32 m0, s38, 4800
    s_nop 0
    buffer_load_dwordx4 v6, s[12:15], s37 offen offset:1536 nt lds
    v_mfma_f32_16x16x32_bf16 a[156:159], v[156:159], v[204:207], a[156:159]
    v_mfma_f32_16x16x32_bf16 a[160:163], v[128:131], v[208:211], a[160:163]
    v_mfma_f32_16x16x32_bf16 a[164:167], v[132:135], v[208:211], a[164:167]
    s_add_u32 m0, s38, 5600
    s_nop 0
    buffer_load_dwordx4 v6, s[12:15], s37 offen offset:1792 nt lds
    v_mfma_f32_16x16x32_bf16 a[168:171], v[136:139], v[208:211], a[168:171]
    v_mfma_f32_16x16x32_bf16 a[172:175], v[140:143], v[208:211], a[172:175]
    s_add_u32 s37, s37, 8192
        s_add_u32 s38, s38, 33792
        s_cmp_ge_u32 s38, s42
        s_cselect_b32 s38, s41, s38
    v_mfma_f32_16x16x32_bf16 a[176:179], v[144:147], v[208:211], a[176:179]
    v_mfma_f32_16x16x32_bf16 a[180:183], v[148:151], v[208:211], a[180:183]
    v_mfma_f32_16x16x32_bf16 a[184:187], v[152:155], v[208:211], a[184:187]
    v_mfma_f32_16x16x32_bf16 a[188:191], v[156:159], v[208:211], a[188:191]
    s_cmp_eq_u32 s5, 0
    s_cbranch_scc0 L_q1_28
    v_mfma_f32_16x16x32_bf16 a[192:195], v[128:131], v[212:215], a[192:195]
    v_mfma_f32_16x16x32_bf16 a[196:199], v[132:135], v[212:215], a[196:199]
    v_mfma_f32_16x16x32_bf16 a[200:203], v[136:139], v[212:215], a[200:203]
    v_mfma_f32_16x16x32_bf16 a[204:207], v[140:143], v[212:215], a[204:207]
    s_branch L_q2_28
L_q1_28:
    v_mfma_f32_16x16x32_bf16 a[192:195], v[144:147], v[212:215], a[192:195]
    v_mfma_f32_16x16x32_bf16 a[196:199], v[148:151], v[212:215], a[196:199]
    v_mfma_f32_16x16x32_bf16 a[200:203], v[152:155], v[212:215], a[200:203]
    v_mfma_f32_16x16x32_bf16 a[204:207], v[156:159], v[212:215], a[204:207]
L_q2_28:
    s_waitcnt lgkmcnt(1)
    v_mfma_f32_16x16x32_bf16 a[160:163], v[96:99], v[180:183], a[160:163]
    ds_read_b128 v[188:191], v243 offset:0
    ds_read_b64_tr_b16 v[128:129], v249 offset:8704
    ds_read_b64_tr_b16 v[130:131], v249 offset:13056
    v_mfma_f32_16x16x32_bf16 a[164:167], v[100:103], v[180:183], a[164:167]
    ds_read_b64_tr_b16 v[132:133], v249 offset:8712
    ds_read_b64_tr_b16 v[134:135], v249 offset:13064
    ds_read_b64_tr_b16 v[136:137], v249 offset:8768
    v_mfma_f32_16x16x32_bf16 a[168:171], v[104:107], v[180:183], a[168:171]
    ds_read_b64_tr_b16 v[138:139], v249 offset:13120
    ds_read_b64_tr_b16 v[140:141], v249 offset:8776
    ds_read_b64_tr_b16 v[142:143], v249 offset:13128
    v_mfma_f32_16x16x32_bf16 a[172:175], v[108:111], v[180:183], a[172:175]
    ds_read_b128 v[192:195], v243 offset:2048
    ds_read_b64_tr_b16 v[144:145], v249 offset:8832
    ds_read_b64_tr_b16 v[146:147], v249 offset:13184
    v_mfma_f32_16x16x32_bf16 a[176:179], v[112:115], v[180:183], a[176:179]
    ds_read_b64_tr_b16 v[148:149], v249 offset:8840
    ds_read_b64_tr_b16 v[150:151], v249 offset:13192
    ds_read_b64_tr_b16 v[152:153], v249 offset:8896
    v_mfma_f32_16x16x32_bf16 a[180:183], v[116:119], v[180:183], a[180:183]
    ds_read_b64_tr_b16 v[154:155], v249 offset:13248
    ds_read_b64_tr_b16 v[156:157], v249 offset:8904
    ds_read_b64_tr_b16 v[158:159], v249 offset:13256
    v_mfma_f32_16x16x32_bf16 a[184:187], v[120:123], v[180:183], a[184:187]
    ds_read_b128 v[196:199], v243 offset:4096
    ds_read_b128 v[200:203], v243 offset:6144
    ds_read_b128 v[204:207], v243 offset:8192
    v_mfma_f32_16x16x32_bf16 a[188:191], v[124:127], v[180:183], a[188:191]
    ds_read_b128 v[208:211], v243 offset:10240
    ds_read_b128 v[212:215], v247
    s_waitcnt lgkmcnt(1)
    v_mfma_f32_16x16x32_bf16 a[160:163], v[128:131], v[208:211], a[160:163]
    v_mfma_f32_16x16x32_bf16 a[164:167], v[132:135], v[208:211], a[164:167]
    s_waitcnt lgkmcnt(0)
    s_barrier
    v_mfma_f32_16x16x32_bf16 a[168:171], v[136:139], v[208:211], a[168:171]
    v_mfma_f32_16x16x32_bf16 a[172:175], v[140:143], v[208:211], a[172:175]
    s_add_u32 m0, s38, 0
    s_nop 0
    buffer_load_dwordx4 v6, s[12:15], s37 offen offset:0 nt lds
    v_mfma_f32_16x16x32_bf16 a[176:179], v[144:147], v[208:211], a[176:179]
    v_mfma_f32_16x16x32_bf16 a[180:183], v[148:151], v[208:211], a[180:183]
    v_mfma_f32_16x16x32_bf16 a[184:187], v[152:155], v[208:211], a[184:187]
    v_mfma_f32_16x16x32_bf16 a[188:191], v[156:159], v[208:211], a[188:191]
    s_cmp_eq_u32 s5, 0
    s_cbranch_scc0 L_q1_29
    v_mfma_f32_16x16x32_bf16 a[192:195], v[96:99], v[184:187], a[192:195]
    v_mfma_f32_16x16x32_bf16 a[196:199], v[100:103], v[184:187], a[196:199]
    v_mfma_f32_16x16x32_bf16 a[200:203], v[104:107], v[184:187], a[200:203]
    v_mfma_f32_16x16x32_bf16 a[204:207], v[108:111], v[184:187], a[204:207]
    v_mfma_f32_16x16x32_bf16 a[192:195], v[128:131], v[212:215], a[192:195]
    v_mfma_f32_16x16x32_bf16 a[196:199], v[132:135], v[212:215], a[196:199]
    v_mfma_f32_16x16x32_bf16 a[200:203], v[136:139], v[212:215], a[200:203]
    v_mfma_f32_16x16x32_bf16 a[204:207], v[140:143], v[212:215], a[204:207]
    s_branch L_q2_29
L_q1_29:
    v_mfma_f32_16x16x32_bf16 a[192:195], v[112:115], v[184:187], a[192:195]
    v_mfma_f32_16x16x32_bf16 a[196:199], v[116:119], v[184:187], a[196:199]
    v_mfma_f32_16x16x32_bf16 a[200:203], v[120:123], v[184:187], a[200:203]
    v_mfma_f32_16x16x32_bf16 a[204:207], v[124:127], v[184:187], a[204:207]
    v_mfma_f32_16x16x32_bf16 a[192:195], v[144:147], v[212:215], a[192:195]
    v_mfma_f32_16x16x32_bf16 a[196:199], v[148:151], v[212:215], a[196:199]
    v_mfma_f32_16x16x32_bf16 a[200:203], v[152:155], v[212:215], a[200:203]
    v_mfma_f32_16x16x32_bf16 a[204:207], v[156:159], v[212:215], a[204:207]
L_q2_29:
    v_mfma_f32_16x16x32_bf16 a[0:3], v[96:99], v[160:163], a[0:3]
    s_add_u32 m0, s38, 800
    s_nop 0
    buffer_load_dwordx4 v6, s[12:15], s37 offen offset:256 nt lds
    v_mfma_f32_16x16x32_bf16 a[4:7], v[100:103], v[160:163], a[4:7]
    v_mfma_f32_16x16x32_bf16 a[8:11], v[104:107], v[160:163], a[8:11]
    v_accvgpr_read_b32 v216, a160
    v_accvgpr_read_b32 v217, a161
    v_accvgpr_read_b32 v218, a162
    v_accvgpr_read_b32 v219, a163
    v_accvgpr_read_b32 v220, a164
    v_accvgpr_read_b32 v221, a165
    v_mfma_f32_16x16x32_bf16 a[12:15], v[108:111], v[160:163], a[12:15]
    v_accvgpr_read_b32 v222, a166
    v_accvgpr_read_b32 v223, a167
    v_pk_mul_f32 v[216:217], v[216:217], s[44:45]
    v_pk_mul_f32 v[218:219], v[218:219], s[44:45]
    v_pk_mul_f32 v[220:221], v[220:221], s[44:45]
    v_pk_mul_f32 v[222:223], v[222:223], s[44:45]
    v_mfma_f32_16x16x32_bf16 a[16:19], v[112:115], v[160:163], a[16:19]
    v_cvt_pk_bf16_f32 v216, v216, v217
    v_cvt_pk_bf16_f32 v218, v218, v219
    v_cvt_pk_bf16_f32 v220, v220, v221
    v_cvt_pk_bf16_f32 v222, v222, v223
    v_accvgpr_write_b32 a224, v216
    v_accvgpr_write_b32 a225, v218
    v_mfma_f32_16x16x32_bf16 a[20:23], v[116:119], v[160:163], a[20:23]
    v_accvgpr_write_b32 a226, v220
    v_accvgpr_write_b32 a227, v222
    v_accvgpr_read_b32 v226, a168
    v_accvgpr_read_b32 v227, a169
    v_accvgpr_read_b32 v228, a170
    v_accvgpr_read_b32 v229, a171
    v_mfma_f32_16x16x32_bf16 a[24:27], v[120:123], v[160:163], a[24:27]
    s_add_u32 m0, s38, 1600
    s_nop 0
    buffer_load_dwordx4 v6, s[12:15], s37 offen offset:512 nt lds
    v_accvgpr_read_b32 v230, a172
    v_accvgpr_read_b32 v231, a173
    v_accvgpr_read_b32 v232, a174
    v_accvgpr_read_b32 v233, a175
    v_pk_mul_f32 v[226:227], v[226:227], s[44:45]
    v_pk_mul_f32 v[228:229], v[228:229], s[44:45]
    v_mfma_f32_16x16x32_bf16 a[28:31], v[124:127], v[160:163], a[28:31]
    v_pk_mul_f32 v[230:231], v[230:231], s[44:45]
    v_pk_mul_f32 v[232:233], v[232:233], s[44:45]
    v_cvt_pk_bf16_f32 v226, v226, v227
    v_cvt_pk_bf16_f32 v228, v228, v229
    v_cvt_pk_bf16_f32 v230, v230, v231
    v_cvt_pk_bf16_f32 v232, v232, v233
    v_mfma_f32_16x16x32_bf16 a[0:3], v[128:131], v[188:191], a[0:3]
    v_accvgpr_write_b32 a228, v226
    v_accvgpr_write_b32 a229, v228
    v_accvgpr_write_b32 a230, v230
    v_accvgpr_write_b32 a231, v232
    v_mfma_f32_32x32x16_bf16 a[160:175], v[236:239], v[236:239], 0
    v_mfma_f32_16x16x32_bf16 a[4:7], v[132:135], v[188:191], a[4:7]
    v_accvgpr_read_b32 v216, a176
    v_accvgpr_read_b32 v217, a177
    v_accvgpr_read_b32 v218, a178
    v_accvgpr_read_b32 v219, a179
    v_accvgpr_read_b32 v220, a180
    v_accvgpr_read_b32 v221, a181
    v_mfma_f32_16x16x32_bf16 a[8:11], v[136:139], v[188:191], a[8:11]
    v_accvgpr_read_b32 v222, a182
    v_accvgpr_read_b32 v223, a183
    v_pk_mul_f32 v[216:217], v[216:217], s[44:45]
    v_pk_mul_f32 v[218:219], v[218:219], s[44:45]
    v_pk_mul_f32 v[220:221], v[220:221], s[44:45]
    v_pk_mul_f32 v[222:223], v[222:223], s[44:45]
    v_mfma_f32_16x16x32_bf16 a[12:15], v[140:143], v[188:191], a[12:15]
    v_cvt_pk_bf16_f32 v216, v216, v217
    v_cvt_pk_bf16_f32 v218, v218, v219
    v_cvt_pk_bf16_f32 v220, v220, v221
    v_cvt_pk_bf16_f32 v222, v222, v223
    v_accvgpr_write_b32 a232, v216
    v_accvgpr_write_b32 a233, v218
    v_mfma_f32_16x16x32_bf16 a[16:19], v[144:147], v[188:191], a[16:19]
    v_accvgpr_write_b32 a234, v220
    v_accvgpr_write_b32 a235, v222
    v_accvgpr_read_b32 v226, a184
    v_accvgpr_read_b32 v227, a185
    v_accvgpr_read_b32 v228, a186
    v_accvgpr_read_b32 v229, a187
    v_mfma_f32_16x16x32_bf16 a[20:23], v[148:151], v[188:191], a[20:23]
    v_accvgpr_read_b32 v230, a188
    v_accvgpr_read_b32 v231, a189
    v_accvgpr_read_b32 v232, a190
    v_accvgpr_read_b32 v233, a191
    v_pk_mul_f32 v[226:227], v[226:227], s[44:45]
    v_pk_mul_f32 v[228:229], v[228:229], s[44:45]
    v_mfma_f32_16x16x32_bf16 a[24:27], v[152:155], v[188:191], a[24:27]
    v_pk_mul_f32 v[230:231], v[230:231], s[44:45]
    v_pk_mul_f32 v[232:233], v[232:233], s[44:45]
    v_cvt_pk_bf16_f32 v226, v226, v227
    v_cvt_pk_bf16_f32 v228, v228, v229
    v_cvt_pk_bf16_f32 v230, v230, v231
    v_cvt_pk_bf16_f32 v232, v232, v233
    v_mfma_f32_16x16x32_bf16 a[28:31], v[156:159], v[188:191], a[28:31]
    v_accvgpr_write_b32 a236, v226
    v_accvgpr_write_b32 a237, v228
    v_accvgpr_write_b32 a238, v230
    v_accvgpr_write_b32 a239, v232
    v_mfma_f32_32x32x16_bf16 a[176:191], v[236:239], v[236:239], 0
    v_mfma_f32_16x16x32_bf16 a[32:35], v[96:99], v[164:167], a[32:35]
    s_lshl_b32 s10, s4, 12
    s_lshl_b32 s11, s5, 11
    s_add_u32 s10, s10, 135168
    s_add_u32 s11, s11, s10
    v_add_u32 v12, s11, v11
    v_add_u32 v13, s10, v11
    v_mfma_f32_16x16x32_bf16 a[36:39], v[100:103], v[164:167], a[36:39]
    v_accvgpr_read_b32 v216, a192
    v_accvgpr_read_b32 v217, a193
    v_accvgpr_read_b32 v218, a194
    v_accvgpr_read_b32 v219, a195
    v_accvgpr_read_b32 v220, a196
    v_mfma_f32_16x16x32_bf16 a[40:43], v[104:107], v[164:167], a[40:43]
    v_accvgpr_read_b32 v221, a197
    v_accvgpr_read_b32 v222, a198
    v_accvgpr_read_b32 v223, a199
    v_pk_mul_f32 v[216:217], v[216:217], s[44:45]
    v_pk_mul_f32 v[218:219], v[218:219], s[44:45]
    v_mfma_f32_16x16x32_bf16 a[44:47], v[108:111], v[164:167], a[44:47]
    v_pk_mul_f32 v[220:221], v[220:221], s[44:45]
    v_pk_mul_f32 v[222:223], v[222:223], s[44:45]
    v_cvt_pk_bf16_f32 v216, v216, v217
    v_cvt_pk_bf16_f32 v217, v218, v219
    v_cvt_pk_bf16_f32 v218, v220, v221
    v_mfma_f32_16x16x32_bf16 a[48:51], v[112:115], v[164:167], a[48:51]
    v_cvt_pk_bf16_f32 v219, v222, v223
    ds_write_b128 v12, v[216:219] offset:0
    v_accvgpr_read_b32 v226, a200
    v_accvgpr_read_b32 v227, a201
    v_accvgpr_read_b32 v228, a202
    v_mfma_f32_16x16x32_bf16 a[52:55], v[116:119], v[164:167], a[52:55]
    v_accvgpr_read_b32 v229, a203
    v_accvgpr_read_b32 v230, a204
    v_accvgpr_read_b32 v231, a205
    v_accvgpr_read_b32 v232, a206
    v_accvgpr_read_b32 v233, a207
    v_mfma_f32_16x16x32_bf16 a[56:59], v[120:123], v[164:167], a[56:59]
    v_pk_mul_f32 v[226:227], v[226:227], s[44:45]
    v_pk_mul_f32 v[228:229], v[228:229], s[44:45]
    v_pk_mul_f32 v[230:231], v[230:231], s[44:45]
    v_pk_mul_f32 v[232:233], v[232:233], s[44:45]
    v_cvt_pk_bf16_f32 v226, v226, v227
    v_mfma_f32_16x16x32_bf16 a[60:63], v[124:127], v[164:167], a[60:63]
    v_cvt_pk_bf16_f32 v227, v228, v229
    v_cvt_pk_bf16_f32 v228, v230, v231
    v_cvt_pk_bf16_f32 v229, v232, v233
    ds_write_b128 v12, v[226:229] offset:1024
    v_mfma_f32_32x32x16_bf16 a[192:207], v[236:239], v[236:239], 0
    v_mfma_f32_16x16x32_bf16 a[32:35], v[128:131], v[192:195], a[32:35]
    v_accvgpr_read_b32 v216, a0
    v_accvgpr_read_b32 v217, a1
    v_accvgpr_read_b32 v218, a2
    v_accvgpr_read_b32 v219, a3
    v_accvgpr_read_b32 v220, a4
    v_accvgpr_read_b32 v221, a5
    v_mfma_f32_16x16x32_bf16 a[36:39], v[132:135], v[192:195], a[36:39]
    v_accvgpr_read_b32 v222, a6
    v_accvgpr_read_b32 v223, a7
    v_pk_mul_f32 v[216:217], v[216:217], s[44:45]
    v_pk_mul_f32 v[218:219], v[218:219], s[44:45]
    v_pk_mul_f32 v[220:221], v[220:221], s[44:45]
    v_mfma_f32_16x16x32_bf16 a[40:43], v[136:139], v[192:195], a[40:43]
    v_pk_mul_f32 v[222:223], v[222:223], s[44:45]
    v_cvt_pk_bf16_f32 v16, v216, v217
    v_cvt_pk_bf16_f32 v17, v218, v219
    v_cvt_pk_bf16_f32 v18, v220, v221
    v_cvt_pk_bf16_f32 v19, v222, v223
    v_accvgpr_read_b32 v226, a8
    v_mfma_f32_16x16x32_bf16 a[44:47], v[140:143], v[192:195], a[44:47]
    v_accvgpr_read_b32 v227, a9
    v_accvgpr_read_b32 v228, a10
    v_accvgpr_read_b32 v229, a11
    v_accvgpr_read_b32 v230, a12
    v_accvgpr_read_b32 v231, a13
    v_mfma_f32_16x16x32_bf16 a[48:51], v[144:147], v[192:195], a[48:51]
    v_accvgpr_read_b32 v232, a14
    v_accvgpr_read_b32 v233, a15
    v_pk_mul_f32 v[226:227], v[226:227], s[44:45]
    v_pk_mul_f32 v[228:229], v[228:229], s[44:45]
    v_pk_mul_f32 v[230:231], v[230:231], s[44:45]
    v_pk_mul_f32 v[232:233], v[232:233], s[44:45]
    v_mfma_f32_16x16x32_bf16 a[52:55], v[148:151], v[192:195], a[52:55]
    v_cvt_pk_bf16_f32 v20, v226, v227
    v_cvt_pk_bf16_f32 v21, v228, v229
    v_cvt_pk_bf16_f32 v22, v230, v231
    v_cvt_pk_bf16_f32 v23, v232, v233
    v_mfma_f32_32x32x16_bf16 a[0:15], v[236:239], v[236:239], 0
    v_mfma_f32_16x16x32_bf16 a[56:59], v[152:155], v[192:195], a[56:59]
    v_accvgpr_read_b32 v216, a16
    v_accvgpr_read_b32 v217, a17
    v_accvgpr_read_b32 v218, a18
    v_accvgpr_read_b32 v219, a19
    v_accvgpr_read_b32 v220, a20
    v_accvgpr_read_b32 v221, a21
    v_mfma_f32_16x16x32_bf16 a[60:63], v[156:159], v[192:195], a[60:63]
    v_accvgpr_read_b32 v222, a22
    v_accvgpr_read_b32 v223, a23
    v_pk_mul_f32 v[216:217], v[216:217], s[44:45]
    v_pk_mul_f32 v[218:219], v[218:219], s[44:45]
    v_pk_mul_f32 v[220:221], v[220:221], s[44:45]
    v_mfma_f32_16x16x32_bf16 a[64:67], v[96:99], v[168:171], a[64:67]
    v_pk_mul_f32 v[222:223], v[222:223], s[44:45]
    v_cvt_pk_bf16_f32 v24, v216, v217
    v_cvt_pk_bf16_f32 v25, v218, v219
    v_cvt_pk_bf16_f32 v26, v220, v221
    v_cvt_pk_bf16_f32 v27, v222, v223
    v_accvgpr_read_b32 v226, a24
    v_mfma_f32_16x16x32_bf16 a[68:71], v[100:103], v[168:171], a[68:71]
    v_accvgpr_read_b32 v227, a25
    v_accvgpr_read_b32 v228, a26
    v_accvgpr_read_b32 v229, a27
    v_accvgpr_read_b32 v230, a28
    v_accvgpr_read_b32 v231, a29
    v_mfma_f32_16x16x32_bf16 a[72:75], v[104:107], v[168:171], a[72:75]
    v_accvgpr_read_b32 v232, a30
    v_accvgpr_read_b32 v233, a31
    v_pk_mul_f32 v[226:227], v[226:227], s[44:45]
    v_pk_mul_f32 v[228:229], v[228:229], s[44:45]
    v_pk_mul_f32 v[230:231], v[230:231], s[44:45]
    v_pk_mul_f32 v[232:233], v[232:233], s[44:45]
    v_mfma_f32_16x16x32_bf16 a[76:79], v[108:111], v[168:171], a[76:79]
    v_cvt_pk_bf16_f32 v28, v226, v227
    v_cvt_pk_bf16_f32 v29, v228, v229
    v_cvt_pk_bf16_f32 v30, v230, v231
    v_cvt_pk_bf16_f32 v31, v232, v233
    v_mfma_f32_32x32x16_bf16 a[16:31], v[236:239], v[236:239], 0
    v_mfma_f32_16x16x32_bf16 a[80:83], v[112:115], v[168:171], a[80:83]
    v_accvgpr_read_b32 v216, a32
    v_accvgpr_read_b32 v217, a33
    v_accvgpr_read_b32 v218, a34
    v_accvgpr_read_b32 v219, a35
    v_accvgpr_read_b32 v220, a36
    v_mfma_f32_16x16x32_bf16 a[84:87], v[116:119], v[168:171], a[84:87]
    v_accvgpr_read_b32 v221, a37
    v_accvgpr_read_b32 v222, a38
    v_accvgpr_read_b32 v223, a39
    v_pk_mul_f32 v[216:217], v[216:217], s[44:45]
    v_pk_mul_f32 v[218:219], v[218:219], s[44:45]
    v_mfma_f32_16x16x32_bf16 a[88:91], v[120:123], v[168:171], a[88:91]
    v_pk_mul_f32 v[220:221], v[220:221], s[44:45]
    v_pk_mul_f32 v[222:223], v[222:223], s[44:45]
    v_cvt_pk_bf16_f32 v32, v216, v217
    v_cvt_pk_bf16_f32 v33, v218, v219
    v_cvt_pk_bf16_f32 v34, v220, v221
    v_mfma_f32_16x16x32_bf16 a[92:95], v[124:127], v[168:171], a[92:95]
    v_cvt_pk_bf16_f32 v35, v222, v223
    v_accvgpr_read_b32 v226, a40
    v_accvgpr_read_b32 v227, a41
    v_accvgpr_read_b32 v228, a42
    v_mfma_f32_16x16x32_bf16 a[64:67], v[128:131], v[196:199], a[64:67]
    v_accvgpr_read_b32 v229, a43
    v_accvgpr_read_b32 v230, a44
    v_accvgpr_read_b32 v231, a45
    v_accvgpr_read_b32 v232, a46
    v_accvgpr_read_b32 v233, a47
    v_mfma_f32_16x16x32_bf16 a[68:71], v[132:135], v[196:199], a[68:71]
    v_pk_mul_f32 v[226:227], v[226:227], s[44:45]
    v_pk_mul_f32 v[228:229], v[228:229], s[44:45]
    v_pk_mul_f32 v[230:231], v[230:231], s[44:45]
    v_pk_mul_f32 v[232:233], v[232:233], s[44:45]
    v_cvt_pk_bf16_f32 v36, v226, v227
    v_mfma_f32_16x16x32_bf16 a[72:75], v[136:139], v[196:199], a[72:75]
    v_cvt_pk_bf16_f32 v37, v228, v229
    v_cvt_pk_bf16_f32 v38, v230, v231
    v_cvt_pk_bf16_f32 v39, v232, v233
    v_mfma_f32_32x32x16_bf16 a[32:47], v[236:239], v[236:239], 0
    v_mfma_f32_16x16x32_bf16 a[76:79], v[140:143], v[196:199], a[76:79]
    v_accvgpr_read_b32 v216, a48
    v_accvgpr_read_b32 v217, a49
    v_accvgpr_read_b32 v218, a50
    v_accvgpr_read_b32 v219, a51
    v_accvgpr_read_b32 v220, a52
    v_mfma_f32_16x16x32_bf16 a[80:83], v[144:147], v[196:199], a[80:83]
    v_accvgpr_read_b32 v221, a53
    v_accvgpr_read_b32 v222, a54
    v_accvgpr_read_b32 v223, a55
    v_pk_mul_f32 v[216:217], v[216:217], s[44:45]
    v_pk_mul_f32 v[218:219], v[218:219], s[44:45]
    v_mfma_f32_16x16x32_bf16 a[84:87], v[148:151], v[196:199], a[84:87]
    v_pk_mul_f32 v[220:221], v[220:221], s[44:45]
    v_pk_mul_f32 v[222:223], v[222:223], s[44:45]
    v_cvt_pk_bf16_f32 v40, v216, v217
    v_cvt_pk_bf16_f32 v41, v218, v219
    v_cvt_pk_bf16_f32 v42, v220, v221
    v_mfma_f32_16x16x32_bf16 a[88:91], v[152:155], v[196:199], a[88:91]
    v_cvt_pk_bf16_f32 v43, v222, v223
    v_accvgpr_read_b32 v226, a56
    v_accvgpr_read_b32 v227, a57
    v_accvgpr_read_b32 v228, a58
    v_mfma_f32_16x16x32_bf16 a[92:95], v[156:159], v[196:199], a[92:95]
    v_accvgpr_read_b32 v229, a59
    v_accvgpr_read_b32 v230, a60
    v_accvgpr_read_b32 v231, a61
    v_accvgpr_read_b32 v232, a62
    v_accvgpr_read_b32 v233, a63
    v_mfma_f32_16x16x32_bf16 a[96:99], v[96:99], v[172:175], a[96:99]
    v_pk_mul_f32 v[226:227], v[226:227], s[44:45]
    v_pk_mul_f32 v[228:229], v[228:229], s[44:45]
    v_pk_mul_f32 v[230:231], v[230:231], s[44:45]
    v_pk_mul_f32 v[232:233], v[232:233], s[44:45]
    v_cvt_pk_bf16_f32 v44, v226, v227
    v_mfma_f32_16x16x32_bf16 a[100:103], v[100:103], v[172:175], a[100:103]
    v_cvt_pk_bf16_f32 v45, v228, v229
    v_cvt_pk_bf16_f32 v46, v230, v231
    v_cvt_pk_bf16_f32 v47, v232, v233
    v_mfma_f32_32x32x16_bf16 a[48:63], v[236:239], v[236:239], 0
    v_mfma_f32_16x16x32_bf16 a[104:107], v[104:107], v[172:175], a[104:107]
    v_accvgpr_read_b32 v216, a64
    v_accvgpr_read_b32 v217, a65
    v_accvgpr_read_b32 v218, a66
    v_accvgpr_read_b32 v219, a67
    v_accvgpr_read_b32 v220, a68
    v_mfma_f32_16x16x32_bf16 a[108:111], v[108:111], v[172:175], a[108:111]
    v_accvgpr_read_b32 v221, a69
    v_accvgpr_read_b32 v222, a70
    v_accvgpr_read_b32 v223, a71
    v_pk_mul_f32 v[216:217], v[216:217], s[44:45]
    v_mfma_f32_16x16x32_bf16 a[112:115], v[112:115], v[172:175], a[112:115]
    v_pk_mul_f32 v[218:219], v[218:219], s[44:45]
    v_pk_mul_f32 v[220:221], v[220:221], s[44:45]
    v_pk_mul_f32 v[222:223], v[222:223], s[44:45]
    v_cvt_pk_bf16_f32 v48, v216, v217
    v_mfma_f32_16x16x32_bf16 a[116:119], v[116:119], v[172:175], a[116:119]
    v_cvt_pk_bf16_f32 v49, v218, v219
    v_cvt_pk_bf16_f32 v50, v220, v221
    v_cvt_pk_bf16_f32 v51, v222, v223
    v_accvgpr_read_b32 v226, a72
    v_mfma_f32_16x16x32_bf16 a[120:123], v[120:123], v[172:175], a[120:123]
    v_accvgpr_read_b32 v227, a73
    v_accvgpr_read_b32 v228, a74
    v_accvgpr_read_b32 v229, a75
    v_accvgpr_read_b32 v230, a76
    v_mfma_f32_16x16x32_bf16 a[124:127], v[124:127], v[172:175], a[124:127]
    v_accvgpr_read_b32 v231, a77
    v_accvgpr_read_b32 v232, a78
    v_accvgpr_read_b32 v233, a79
    v_pk_mul_f32 v[226:227], v[226:227], s[44:45]
    v_mfma_f32_16x16x32_bf16 a[96:99], v[128:131], v[200:203], a[96:99]
    v_pk_mul_f32 v[228:229], v[228:229], s[44:45]
    v_pk_mul_f32 v[230:231], v[230:231], s[44:45]
    v_pk_mul_f32 v[232:233], v[232:233], s[44:45]
    v_cvt_pk_bf16_f32 v52, v226, v227
    v_mfma_f32_16x16x32_bf16 a[100:103], v[132:135], v[200:203], a[100:103]
    v_cvt_pk_bf16_f32 v53, v228, v229
    v_cvt_pk_bf16_f32 v54, v230, v231
    v_cvt_pk_bf16_f32 v55, v232, v233
    v_mfma_f32_32x32x16_bf16 a[64:79], v[236:239], v[236:239], 0
    v_mfma_f32_16x16x32_bf16 a[104:107], v[136:139], v[200:203], a[104:107]
    v_accvgpr_read_b32 v216, a80
    v_accvgpr_read_b32 v217, a81
    v_accvgpr_read_b32 v218, a82
    v_accvgpr_read_b32 v219, a83
    v_accvgpr_read_b32 v220, a84
    v_mfma_f32_16x16x32_bf16 a[108:111], v[140:143], v[200:203], a[108:111]
    v_accvgpr_read_b32 v221, a85
    v_accvgpr_read_b32 v222, a86
    v_accvgpr_read_b32 v223, a87
    v_pk_mul_f32 v[216:217], v[216:217], s[44:45]
    v_mfma_f32_16x16x32_bf16 a[112:115], v[144:147], v[200:203], a[112:115]
    v_pk_mul_f32 v[218:219], v[218:219], s[44:45]
    v_pk_mul_f32 v[220:221], v[220:221], s[44:45]
    v_pk_mul_f32 v[222:223], v[222:223], s[44:45]
    v_cvt_pk_bf16_f32 v56, v216, v217
    v_mfma_f32_16x16x32_bf16 a[116:119], v[148:151], v[200:203], a[116:119]
    v_cvt_pk_bf16_f32 v57, v218, v219
    v_cvt_pk_bf16_f32 v58, v220, v221
    v_cvt_pk_bf16_f32 v59, v222, v223
    v_accvgpr_read_b32 v226, a88
    v_mfma_f32_16x16x32_bf16 a[120:123], v[152:155], v[200:203], a[120:123]
    v_accvgpr_read_b32 v227, a89
    v_accvgpr_read_b32 v228, a90
    v_accvgpr_read_b32 v229, a91
    v_accvgpr_read_b32 v230, a92
    v_mfma_f32_16x16x32_bf16 a[124:127], v[156:159], v[200:203], a[124:127]
    v_accvgpr_read_b32 v231, a93
    v_accvgpr_read_b32 v232, a94
    v_accvgpr_read_b32 v233, a95
    v_pk_mul_f32 v[226:227], v[226:227], s[44:45]
    v_mfma_f32_16x16x32_bf16 a[128:131], v[96:99], v[176:179], a[128:131]
    v_pk_mul_f32 v[228:229], v[228:229], s[44:45]
    v_pk_mul_f32 v[230:231], v[230:231], s[44:45]
    v_pk_mul_f32 v[232:233], v[232:233], s[44:45]
    v_cvt_pk_bf16_f32 v60, v226, v227
    v_mfma_f32_16x16x32_bf16 a[132:135], v[100:103], v[176:179], a[132:135]
    v_cvt_pk_bf16_f32 v61, v228, v229
    v_cvt_pk_bf16_f32 v62, v230, v231
    v_cvt_pk_bf16_f32 v63, v232, v233
    v_mfma_f32_32x32x16_bf16 a[80:95], v[236:239], v[236:239], 0
    v_mfma_f32_16x16x32_bf16 a[136:139], v[104:107], v[176:179], a[136:139]
    v_mfma_f32_16x16x32_bf16 a[140:143], v[108:111], v[176:179], a[140:143]
    v_accvgpr_read_b32 v216, a96
    v_accvgpr_read_b32 v217, a97
    v_accvgpr_read_b32 v218, a98
    v_accvgpr_read_b32 v219, a99
    v_accvgpr_read_b32 v220, a100
    v_accvgpr_read_b32 v221, a101
    v_mfma_f32_16x16x32_bf16 a[144:147], v[112:115], v[176:179], a[144:147]
    v_accvgpr_read_b32 v222, a102
    v_accvgpr_read_b32 v223, a103
    v_pk_mul_f32 v[216:217], v[216:217], s[44:45]
    v_pk_mul_f32 v[218:219], v[218:219], s[44:45]
    v_pk_mul_f32 v[220:221], v[220:221], s[44:45]
    v_mfma_f32_16x16x32_bf16 a[148:151], v[116:119], v[176:179], a[148:151]
    v_pk_mul_f32 v[222:223], v[222:223], s[44:45]
    v_cvt_pk_bf16_f32 v64, v216, v217
    v_cvt_pk_bf16_f32 v65, v218, v219
    v_cvt_pk_bf16_f32 v66, v220, v221
    v_cvt_pk_bf16_f32 v67, v222, v223
    v_mfma_f32_16x16x32_bf16 a[152:155], v[120:123], v[176:179], a[152:155]
    v_accvgpr_read_b32 v226, a104
    v_accvgpr_read_b32 v227, a105
    v_accvgpr_read_b32 v228, a106
    v_accvgpr_read_b32 v229, a107
    v_accvgpr_read_b32 v230, a108
    v_mfma_f32_16x16x32_bf16 a[156:159], v[124:127], v[176:179], a[156:159]
    v_accvgpr_read_b32 v231, a109
    v_accvgpr_read_b32 v232, a110
    v_accvgpr_read_b32 v233, a111
    v_pk_mul_f32 v[226:227], v[226:227], s[44:45]
    v_pk_mul_f32 v[228:229], v[228:229], s[44:45]
    v_mfma_f32_16x16x32_bf16 a[128:131], v[128:131], v[204:207], a[128:131]
    v_pk_mul_f32 v[230:231], v[230:231], s[44:45]
    v_pk_mul_f32 v[232:233], v[232:233], s[44:45]
    v_cvt_pk_bf16_f32 v68, v226, v227
    v_cvt_pk_bf16_f32 v69, v228, v229
    v_cvt_pk_bf16_f32 v70, v230, v231
    v_mfma_f32_16x16x32_bf16 a[132:135], v[132:135], v[204:207], a[132:135]
    v_cvt_pk_bf16_f32 v71, v232, v233
    v_mfma_f32_32x32x16_bf16 a[96:111], v[236:239], v[236:239], 0
    v_accvgpr_read_b32 v216, a112
    v_accvgpr_read_b32 v217, a113
    v_accvgpr_read_b32 v218, a114
    v_mfma_f32_16x16x32_bf16 a[136:139], v[136:139], v[204:207], a[136:139]
    v_accvgpr_read_b32 v219, a115
    v_accvgpr_read_b32 v220, a116
    v_accvgpr_read_b32 v221, a117
    v_accvgpr_read_b32 v222, a118
    v_accvgpr_read_b32 v223, a119
    v_mfma_f32_16x16x32_bf16 a[140:143], v[140:143], v[204:207], a[140:143]
    v_pk_mul_f32 v[216:217], v[216:217], s[44:45]
    v_pk_mul_f32 v[218:219], v[218:219], s[44:45]
    v_pk_mul_f32 v[220:221], v[220:221], s[44:45]
    v_pk_mul_f32 v[222:223], v[222:223], s[44:45]
    v_cvt_pk_bf16_f32 v72, v216, v217
    v_mfma_f32_16x16x32_bf16 a[144:147], v[144:147], v[204:207], a[144:147]
    v_cvt_pk_bf16_f32 v73, v218, v219
    v_cvt_pk_bf16_f32 v74, v220, v221
    v_cvt_pk_bf16_f32 v75, v222, v223
    v_accvgpr_read_b32 v226, a120
    v_accvgpr_read_b32 v227, a121
    v_mfma_f32_16x16x32_bf16 a[148:151], v[148:151], v[204:207], a[148:151]
    v_accvgpr_read_b32 v228, a122
    v_accvgpr_read_b32 v229, a123
    v_accvgpr_read_b32 v230, a124
    v_accvgpr_read_b32 v231, a125
    v_accvgpr_read_b32 v232, a126
    v_mfma_f32_16x16x32_bf16 a[152:155], v[152:155], v[204:207], a[152:155]
    v_accvgpr_read_b32 v233, a127
    v_pk_mul_f32 v[226:227], v[226:227], s[44:45]
    v_pk_mul_f32 v[228:229], v[228:229], s[44:45]
    v_pk_mul_f32 v[230:231], v[230:231], s[44:45]
    v_pk_mul_f32 v[232:233], v[232:233], s[44:45]
    v_mfma_f32_16x16x32_bf16 a[156:159], v[156:159], v[204:207], a[156:159]
    v_cvt_pk_bf16_f32 v76, v226, v227
    v_cvt_pk_bf16_f32 v77, v228, v229
    v_cvt_pk_bf16_f32 v78, v230, v231
    v_cvt_pk_bf16_f32 v79, v232, v233
    v_mfma_f32_32x32x16_bf16 a[112:127], v[236:239], v[236:239], 0
    v_accvgpr_read_b32 v216, a128
    v_accvgpr_read_b32 v217, a129
    v_accvgpr_read_b32 v218, a130
    v_accvgpr_read_b32 v219, a131
    v_accvgpr_read_b32 v220, a132
    v_accvgpr_read_b32 v221, a133
    v_accvgpr_read_b32 v222, a134
    v_accvgpr_read_b32 v223, a135
    v_pk_mul_f32 v[216:217], v[216:217], s[44:45]
    v_pk_mul_f32 v[218:219], v[218:219], s[44:45]
    v_pk_mul_f32 v[220:221], v[220:221], s[44:45]
    v_pk_mul_f32 v[222:223], v[222:223], s[44:45]
    v_cvt_pk_bf16_f32 v80, v216, v217
    v_cvt_pk_bf16_f32 v81, v218, v219
    v_cvt_pk_bf16_f32 v82, v220, v221
    v_cvt_pk_bf16_f32 v83, v222, v223
    v_accvgpr_read_b32 v226, a136
    v_accvgpr_read_b32 v227, a137
    v_accvgpr_read_b32 v228, a138
    v_accvgpr_read_b32 v229, a139
    v_accvgpr_read_b32 v230, a140
    v_accvgpr_read_b32 v231, a141
    v_accvgpr_read_b32 v232, a142
    v_accvgpr_read_b32 v233, a143
    v_pk_mul_f32 v[226:227], v[226:227], s[44:45]
    v_pk_mul_f32 v[228:229], v[228:229], s[44:45]
    v_pk_mul_f32 v[230:231], v[230:231], s[44:45]
    v_pk_mul_f32 v[232:233], v[232:233], s[44:45]
    v_cvt_pk_bf16_f32 v84, v226, v227
    v_cvt_pk_bf16_f32 v85, v228, v229
    v_cvt_pk_bf16_f32 v86, v230, v231
    v_cvt_pk_bf16_f32 v87, v232, v233
    v_mfma_f32_32x32x16_bf16 a[128:143], v[236:239], v[236:239], 0
    v_accvgpr_read_b32 v216, a144
    v_accvgpr_read_b32 v217, a145
    v_accvgpr_read_b32 v218, a146
    v_accvgpr_read_b32 v219, a147
    v_accvgpr_read_b32 v220, a148
    v_accvgpr_read_b32 v221, a149
    v_accvgpr_read_b32 v222, a150
    v_accvgpr_read_b32 v223, a151
    v_pk_mul_f32 v[216:217], v[216:217], s[44:45]
    v_pk_mul_f32 v[218:219], v[218:219], s[44:45]
    v_pk_mul_f32 v[220:221], v[220:221], s[44:45]
    v_pk_mul_f32 v[222:223], v[222:223], s[44:45]
    v_cvt_pk_bf16_f32 v88, v216, v217
    v_cvt_pk_bf16_f32 v89, v218, v219
    v_cvt_pk_bf16_f32 v90, v220, v221
    v_cvt_pk_bf16_f32 v91, v222, v223
    v_accvgpr_read_b32 v226, a152
    v_accvgpr_read_b32 v227, a153
    v_accvgpr_read_b32 v228, a154
    v_accvgpr_read_b32 v229, a155
    v_accvgpr_read_b32 v230, a156
    v_accvgpr_read_b32 v231, a157
    v_accvgpr_read_b32 v232, a158
    v_accvgpr_read_b32 v233, a159
    v_pk_mul_f32 v[226:227], v[226:227], s[44:45]
    v_pk_mul_f32 v[228:229], v[228:229], s[44:45]
    v_pk_mul_f32 v[230:231], v[230:231], s[44:45]
    v_pk_mul_f32 v[232:233], v[232:233], s[44:45]
    v_cvt_pk_bf16_f32 v92, v226, v227
    v_cvt_pk_bf16_f32 v93, v228, v229
    v_cvt_pk_bf16_f32 v94, v230, v231
    v_cvt_pk_bf16_f32 v95, v232, v233
    v_mfma_f32_32x32x16_bf16 a[144:159], v[236:239], v[236:239], 0
    v_mov_b32 v196, 0
    v_mov_b32 v197, 0
    v_mov_b32 v198, 0
    v_mov_b32 v199, 0
    v_mov_b32 v200, 0
    v_mov_b32 v201, 0
    v_mov_b32 v202, 0
    v_mov_b32 v203, 0
    v_mov_b32 v204, 0
    v_mov_b32 v205, 0
    v_mov_b32 v206, 0
    v_mov_b32 v207, 0
    v_mov_b32 v2, v4
    v_mov_b32 v3, v5
    s_mov_b32 s39, 33792
    s_waitcnt lgkmcnt(0) vmcnt(19)
    s_barrier
    ds_read_b128 v[96:99], v2 offset:0
    ds_read_b128 v[112:115], v2 offset:512
    ds_read_b128 v[100:103], v2 offset:64
    ds_read_b128 v[116:119], v2 offset:576
    ds_read_b128 v[104:107], v2 offset:128
    ds_read_b128 v[120:123], v2 offset:640
    ds_read_b128 v[108:111], v2 offset:192
    ds_read_b128 v[124:127], v2 offset:704
    ds_read_b128 a[240:243], v13 offset:0
    ds_read_b128 a[244:247], v13 offset:1024
    ds_read_b128 a[248:251], v13 offset:2048
    ds_read_b128 a[252:255], v13 offset:3072
    ds_read_b64_tr_b16 v[128:129], v3 offset:0
    ds_read_b64_tr_b16 v[130:131], v3 offset:512
    ds_read_b64_tr_b16 v[132:133], v3 offset:32
    ds_read_b64_tr_b16 v[134:135], v3 offset:544
    ds_read_b64_tr_b16 v[136:137], v3 offset:64
    ds_read_b64_tr_b16 v[138:139], v3 offset:576
    ds_read_b64_tr_b16 v[140:141], v3 offset:96
    ds_read_b64_tr_b16 v[142:143], v3 offset:608
    ds_read_b64_tr_b16 v[144:145], v3 offset:128
    ds_read_b64_tr_b16 v[146:147], v3 offset:640
    ds_read_b64_tr_b16 v[148:149], v3 offset:160
    ds_read_b64_tr_b16 v[150:151], v3 offset:672
    ds_read_b64_tr_b16 v[152:153], v3 offset:192
    ds_read_b64_tr_b16 v[154:155], v3 offset:704
    ds_read_b64_tr_b16 v[156:157], v3 offset:224
    ds_read_b64_tr_b16 v[158:159], v3 offset:736
    v_mov_b32 v168, 0
    v_mov_b32 v169, 0
    v_mov_b32 v170, 0
    v_mov_b32 v171, 0
    v_mov_b32 v172, 0
    v_mov_b32 v173, 0
    v_mov_b32 v174, 0xff800000
    v_mov_b32 v175, 0xff800000
    v_mov_b32 v176, 0
    v_mov_b32 v177, 0
    v_mov_b32 v178, 0
    v_mov_b32 v179, 0
    v_mov_b32 v180, 0xff800000
    v_mov_b32 v181, 0xff800000
    v_mov_b32 v182, 0xff800000
    v_mov_b32 v183, 0xff800000
    s_waitcnt lgkmcnt(0)
    v_mov_b32 v224, 0
    v_mov_b32 v225, 0
    v_mov_b32 v226, 0
    v_mov_b32 v227, 0
    v_mov_b32 v228, 0
    v_mov_b32 v229, 0
    v_mov_b32 v230, 0
    v_mov_b32 v231, 0
    v_mov_b32 v232, 0
    v_mov_b32 v233, 0
    v_mov_b32 v234, 0
    v_mov_b32 v235, 0
    v_mov_b32 v236, 0
    v_mov_b32 v237, 0
    v_mov_b32 v238, 0
    v_mov_b32 v239, 0
    v_mov_b32 v240, 0
    v_mov_b32 v241, 0
    v_mov_b32 v242, 0
    v_mov_b32 v243, 0
    v_mov_b32 v244, 0
    v_mov_b32 v245, 0
    v_mov_b32 v246, 0
    v_mov_b32 v247, 0
    v_mov_b32 v248, 0
    v_mov_b32 v249, 0
    v_mov_b32 v250, 0
    v_mov_b32 v251, 0
    v_mov_b32 v12, 0x3f803f80
    v_mov_b32 v13, 0x3f803f80
    v_mov_b32 v14, 0x3f803f80
    v_mov_b32 v15, 0x3f803f80
    s_cmp_eq_u32 s5, 0
    s_cbranch_scc0 L_body1
L_body0:
    s_waitcnt lgkmcnt(0)
    v_mfma_f32_16x16x32_bf16 v[160:163], v[96:99], v[16:19], 0
    v_exp_f32 v174, v174
    v_mfma_f32_16x16x32_bf16 v[164:167], v[112:115], v[16:19], 0
    v_cvt_pk_bf16_f32 v198, v172, v173
    v_exp_f32 v180, v180
    v_mfma_f32_16x16x32_bf16 v[160:163], v[100:103], v[20:23], v[160:163]
    v_exp_f32 v175, v175
    v_mfma_f32_16x16x32_bf16 v[164:167], v[116:119], v[20:23], v[164:167]
    s_add_u32 m0, s38, 2400
    v_cvt_pk_bf16_f32 v201, v178, v179
    v_mfma_f32_16x16x32_bf16 v[160:163], v[104:107], v[24:27], v[160:163]
    buffer_load_dwordx4 v6, s[12:15], s37 offen offset:768 nt lds
    v_mfma_f32_16x16x32_bf16 v[164:167], v[120:123], v[24:27], v[164:167]
    v_cvt_pk_bf16_f32 v199, v174, v175
    v_mfma_f32_16x16x32_bf16 v[160:163], v[108:111], v[28:31], v[160:163]
    v_exp_f32 v181, v181
    v_mfma_f32_16x16x32_bf16 v[164:167], v[124:127], v[28:31], v[164:167]
    v_mfma_f32_16x16x32_bf16 a[128:131], v[128:131], v[196:199], a[128:131]
    v_mfma_f32_16x16x32_bf16 a[132:135], v[132:135], v[196:199], a[132:135]
    v_exp_f32 v182, v182
    v_mfma_f32_16x16x32_bf16 a[136:139], v[136:139], v[196:199], a[136:139]
    v_mfma_f32_16x16x32_bf16 a[140:143], v[140:143], v[196:199], a[140:143]
    s_nop 0
    v_exp_f32 v160, v160
    v_mfma_f32_16x16x32_bf16 a[144:147], v[144:147], v[196:199], a[144:147]
    v_cvt_pk_bf16_f32 v202, v180, v181
    v_mfma_f32_16x16x32_bf16 a[148:151], v[148:151], v[196:199], a[148:151]
    v_exp_f32 v161, v161
    v_mfma_f32_16x16x32_bf16 a[152:155], v[152:155], v[196:199], a[152:155]
    v_mfma_f32_16x16x32_bf16 a[156:159], v[156:159], v[196:199], a[156:159]
    v_exp_f32 v162, v162
    v_mfma_f32_16x16x32_bf16 v[240:243], v[12:15], v[196:199], v[240:243]
    s_add_u32 m0, s38, 3200
    v_mfma_f32_16x16x32_bf16 v[168:171], v[96:99], v[32:35], 0
    buffer_load_dwordx4 v6, s[12:15], s37 offen offset:1024 nt lds
    v_mfma_f32_16x16x32_bf16 v[172:175], v[112:115], v[32:35], 0
    v_exp_f32 v183, v183
    v_mfma_f32_16x16x32_bf16 v[168:171], v[100:103], v[36:39], v[168:171]
    v_cvt_pk_bf16_f32 v203, v182, v183
    v_cvt_pk_bf16_f32 v192, v160, v161
    v_mfma_f32_16x16x32_bf16 v[172:175], v[116:119], v[36:39], v[172:175]
    v_exp_f32 v163, v163
    v_mfma_f32_16x16x32_bf16 v[168:171], v[104:107], v[40:43], v[168:171]
    v_mfma_f32_16x16x32_bf16 v[172:175], v[120:123], v[40:43], v[172:175]
    v_exp_f32 v164, v164
    v_mfma_f32_16x16x32_bf16 v[168:171], v[108:111], v[44:47], v[168:171]
    v_mfma_f32_16x16x32_bf16 v[172:175], v[124:127], v[44:47], v[172:175]
    v_mfma_f32_16x16x32_bf16 a[160:163], v[128:131], v[200:203], a[160:163]
    ds_read_b64_tr_b16 v[128:129], v3 offset:0
    v_cvt_pk_bf16_f32 v193, v162, v163
    v_mfma_f32_16x16x32_bf16 a[164:167], v[132:135], v[200:203], a[164:167]
    ds_read_b64_tr_b16 v[130:131], v3 offset:512
    v_mfma_f32_16x16x32_bf16 a[168:171], v[136:139], v[200:203], a[168:171]
    ds_read_b64_tr_b16 v[132:133], v3 offset:32
    ds_read_b64_tr_b16 v[134:135], v3 offset:544
    v_mfma_f32_16x16x32_bf16 a[172:175], v[140:143], v[200:203], a[172:175]
    ds_read_b64_tr_b16 v[136:137], v3 offset:64
    ds_read_b64_tr_b16 v[138:139], v3 offset:576
    v_exp_f32 v165, v165
    v_mfma_f32_16x16x32_bf16 a[176:179], v[144:147], v[200:203], a[176:179]
    ds_read_b64_tr_b16 v[140:141], v3 offset:96
    ds_read_b64_tr_b16 v[142:143], v3 offset:608
    v_mfma_f32_16x16x32_bf16 a[180:183], v[148:151], v[200:203], a[180:183]
    ds_read_b64_tr_b16 v[144:145], v3 offset:128
    ds_read_b64_tr_b16 v[146:147], v3 offset:640
    v_exp_f32 v166, v166
    v_mfma_f32_16x16x32_bf16 a[184:187], v[152:155], v[200:203], a[184:187]
    ds_read_b64_tr_b16 v[148:149], v3 offset:160
    ds_read_b64_tr_b16 v[150:151], v3 offset:672
    v_mfma_f32_16x16x32_bf16 a[188:191], v[156:159], v[200:203], a[188:191]
    ds_read_b64_tr_b16 v[152:153], v3 offset:192
    ds_read_b64_tr_b16 v[154:155], v3 offset:704
    v_mfma_f32_16x16x32_bf16 v[244:247], v[12:15], v[200:203], v[244:247]
    ds_read_b64_tr_b16 v[156:157], v3 offset:224
    ds_read_b64_tr_b16 v[158:159], v3 offset:736
    v_mfma_f32_16x16x32_bf16 v[176:179], v[96:99], v[48:51], 0
    s_add_u32 m0, s38, 4000
    v_cvt_pk_bf16_f32 v194, v164, v165
    v_exp_f32 v168, v168
    v_mfma_f32_16x16x32_bf16 v[180:183], v[112:115], v[48:51], 0
    buffer_load_dwordx4 v6, s[12:15], s37 offen offset:1280 nt lds
    v_mfma_f32_16x16x32_bf16 v[176:179], v[100:103], v[52:55], v[176:179]
    v_exp_f32 v167, v167
    v_exp_f32 v169, v169
    v_mfma_f32_16x16x32_bf16 v[180:183], v[116:119], v[52:55], v[180:183]
    v_exp_f32 v170, v170
    v_mfma_f32_16x16x32_bf16 v[176:179], v[104:107], v[56:59], v[176:179]
    v_cvt_pk_bf16_f32 v195, v166, v167
    v_mfma_f32_16x16x32_bf16 v[180:183], v[120:123], v[56:59], v[180:183]
    v_cvt_pk_bf16_f32 v196, v168, v169
    v_mfma_f32_16x16x32_bf16 v[176:179], v[108:111], v[60:63], v[176:179]
    v_exp_f32 v171, v171
    v_mfma_f32_16x16x32_bf16 v[180:183], v[124:127], v[60:63], v[180:183]
    v_exp_f32 v172, v172
    v_mfma_f32_16x16x32_bf16 v[184:187], v[96:99], a[240:243], 0
    v_cvt_pk_bf16_f32 v197, v170, v171
    v_mfma_f32_16x16x32_bf16 v[184:187], v[100:103], a[244:247], v[184:187]
    v_mfma_f32_16x16x32_bf16 v[184:187], v[104:107], a[248:251], v[184:187]
    v_exp_f32 v173, v173
    v_mfma_f32_16x16x32_bf16 v[184:187], v[108:111], a[252:255], v[184:187]
    v_exp_f32 v174, v174
    s_waitcnt lgkmcnt(0)
    v_mfma_f32_16x16x32_bf16 a[0:3], v[128:131], v[192:195], a[0:3]
    v_mfma_f32_16x16x32_bf16 a[4:7], v[132:135], v[192:195], a[4:7]
    s_add_u32 m0, s38, 4800
    v_mfma_f32_16x16x32_bf16 a[8:11], v[136:139], v[192:195], a[8:11]
    buffer_load_dwordx4 v6, s[12:15], s37 offen offset:1536 nt lds
    v_mfma_f32_16x16x32_bf16 a[12:15], v[140:143], v[192:195], a[12:15]
    v_cvt_pk_bf16_f32 v198, v172, v173
    v_mfma_f32_16x16x32_bf16 a[16:19], v[144:147], v[192:195], a[16:19]
    v_exp_f32 v175, v175
    v_mfma_f32_16x16x32_bf16 a[20:23], v[148:151], v[192:195], a[20:23]
    v_cvt_pk_bf16_f32 v199, v174, v175
    v_mfma_f32_16x16x32_bf16 a[24:27], v[152:155], v[192:195], a[24:27]
    v_exp_f32 v176, v176
    v_mfma_f32_16x16x32_bf16 a[28:31], v[156:159], v[192:195], a[28:31]
    v_exp_f32 v177, v177
    v_mfma_f32_16x16x32_bf16 v[224:227], v[12:15], v[192:195], v[224:227]
    v_exp_f32 v178, v178
    v_mfma_f32_16x16x32_bf16 v[160:163], v[96:99], v[64:67], 0
    v_cvt_pk_bf16_f32 v200, v176, v177
    v_mfma_f32_16x16x32_bf16 v[164:167], v[112:115], v[64:67], 0
    v_exp_f32 v179, v179
    v_mfma_f32_16x16x32_bf16 v[160:163], v[100:103], v[68:71], v[160:163]
    v_exp_f32 v180, v180
    v_mfma_f32_16x16x32_bf16 v[164:167], v[116:119], v[68:71], v[164:167]
    v_cvt_pk_bf16_f32 v201, v178, v179
    v_mfma_f32_16x16x32_bf16 v[160:163], v[104:107], v[72:75], v[160:163]
    v_exp_f32 v181, v181
    v_exp_f32 v184, v184
    v_mfma_f32_16x16x32_bf16 v[164:167], v[120:123], v[72:75], v[164:167]
    v_exp_f32 v182, v182
    v_mfma_f32_16x16x32_bf16 v[160:163], v[108:111], v[76:79], v[160:163]
    v_exp_f32 v185, v185
    v_mfma_f32_16x16x32_bf16 v[164:167], v[124:127], v[76:79], v[164:167]
    s_add_u32 m0, s38, 5600
    v_mfma_f32_16x16x32_bf16 a[32:35], v[128:131], v[196:199], a[32:35]
    buffer_load_dwordx4 v6, s[12:15], s37 offen offset:1792 nt lds
    v_mfma_f32_16x16x32_bf16 a[36:39], v[132:135], v[196:199], a[36:39]
    v_cvt_pk_bf16_f32 v202, v180, v181
    v_exp_f32 v186, v186
    v_mfma_f32_16x16x32_bf16 a[40:43], v[136:139], v[196:199], a[40:43]
    v_exp_f32 v183, v183
    v_mfma_f32_16x16x32_bf16 a[44:47], v[140:143], v[196:199], a[44:47]
    v_cvt_pk_bf16_f32 v203, v182, v183
    v_mfma_f32_16x16x32_bf16 a[48:51], v[144:147], v[196:199], a[48:51]
    v_cvt_pk_bf16_f32 v204, v184, v185
    v_mfma_f32_16x16x32_bf16 a[52:55], v[148:151], v[196:199], a[52:55]
    v_exp_f32 v187, v187
    v_mfma_f32_16x16x32_bf16 a[56:59], v[152:155], v[196:199], a[56:59]
    v_exp_f32 v160, v160
    v_mfma_f32_16x16x32_bf16 a[60:63], v[156:159], v[196:199], a[60:63]
    v_cvt_pk_bf16_f32 v205, v186, v187
    v_exp_f32 v161, v161
    v_mfma_f32_16x16x32_bf16 v[228:231], v[12:15], v[196:199], v[228:231]
    v_exp_f32 v162, v162
    v_mfma_f32_16x16x32_bf16 v[168:171], v[96:99], v[80:83], 0
    v_cvt_pk_bf16_f32 v192, v160, v161
    v_mfma_f32_16x16x32_bf16 v[172:175], v[112:115], v[80:83], 0
    v_exp_f32 v163, v163
    v_mfma_f32_16x16x32_bf16 v[168:171], v[100:103], v[84:87], v[168:171]
    v_mfma_f32_16x16x32_bf16 v[172:175], v[116:119], v[84:87], v[172:175]
    v_exp_f32 v164, v164
    v_mfma_f32_16x16x32_bf16 v[168:171], v[104:107], v[88:91], v[168:171]
    v_mfma_f32_16x16x32_bf16 v[172:175], v[120:123], v[88:91], v[172:175]
    v_cvt_pk_bf16_f32 v193, v162, v163
    v_mfma_f32_16x16x32_bf16 v[168:171], v[108:111], v[92:95], v[168:171]
    v_exp_f32 v165, v165
    v_mfma_f32_16x16x32_bf16 v[172:175], v[124:127], v[92:95], v[172:175]
    v_mfma_f32_16x16x32_bf16 a[64:67], v[128:131], v[200:203], a[64:67]
    v_exp_f32 v166, v166
    v_mfma_f32_16x16x32_bf16 a[68:71], v[132:135], v[200:203], a[68:71]
    v_mfma_f32_16x16x32_bf16 a[72:75], v[136:139], v[200:203], a[72:75]
    v_cvt_pk_bf16_f32 v194, v164, v165
    v_add_u32 v2, s39, v4
    v_mfma_f32_16x16x32_bf16 a[76:79], v[140:143], v[200:203], a[76:79]
    v_exp_f32 v167, v167
    v_mfma_f32_16x16x32_bf16 a[80:83], v[144:147], v[200:203], a[80:83]
    v_mfma_f32_16x16x32_bf16 a[84:87], v[148:151], v[200:203], a[84:87]
    v_cvt_pk_bf16_f32 v195, v166, v167
    v_mfma_f32_16x16x32_bf16 a[88:91], v[152:155], v[200:203], a[88:91]
    v_mfma_f32_16x16x32_bf16 a[92:95], v[156:159], v[200:203], a[92:95]
    v_exp_f32 v168, v168
    v_mfma_f32_16x16x32_bf16 v[232:235], v[12:15], v[200:203], v[232:235]
    v_exp_f32 v169, v169
    s_waitcnt vmcnt(16) lgkmcnt(0)
    s_barrier
    s_add_u32 s37, s37, 8192
        s_add_u32 s38, s38, 33792
        s_cmp_ge_u32 s38, s42
        s_cselect_b32 s38, s41, s38
    v_exp_f32 v170, v170
    v_mfma_f32_16x16x32_bf16 v[176:179], v[96:99], a[224:227], 0
    ds_read_b128 v[96:99], v2 offset:0
    v_mfma_f32_16x16x32_bf16 v[180:183], v[112:115], a[224:227], 0
    ds_read_b128 v[112:115], v2 offset:512
    s_add_u32 m0, s38, 0
    v_mfma_f32_16x16x32_bf16 v[176:179], v[100:103], a[228:231], v[176:179]
    ds_read_b128 v[100:103], v2 offset:64
    buffer_load_dwordx4 v6, s[12:15], s37 offen offset:0 nt lds
    v_mfma_f32_16x16x32_bf16 v[180:183], v[116:119], a[228:231], v[180:183]
    ds_read_b128 v[116:119], v2 offset:576
    v_cvt_pk_bf16_f32 v196, v168, v169
    v_mfma_f32_16x16x32_bf16 v[176:179], v[104:107], a[232:235], v[176:179]
    ds_read_b128 v[104:107], v2 offset:128
    v_exp_f32 v171, v171
    v_mfma_f32_16x16x32_bf16 v[180:183], v[120:123], a[232:235], v[180:183]
    ds_read_b128 v[120:123], v2 offset:640
    v_exp_f32 v172, v172
    v_mfma_f32_16x16x32_bf16 v[176:179], v[108:111], a[236:239], v[176:179]
    ds_read_b128 v[108:111], v2 offset:192
    v_mfma_f32_16x16x32_bf16 v[180:183], v[124:127], a[236:239], v[180:183]
    ds_read_b128 v[124:127], v2 offset:704
    v_mfma_f32_16x16x32_bf16 a[96:99], v[128:131], v[192:195], a[96:99]
    v_cvt_pk_bf16_f32 v197, v170, v171
    v_mfma_f32_16x16x32_bf16 a[100:103], v[132:135], v[192:195], a[100:103]
    s_add_u32 m0, s38, 800
    v_mfma_f32_16x16x32_bf16 a[104:107], v[136:139], v[192:195], a[104:107]
    buffer_load_dwordx4 v6, s[12:15], s37 offen offset:256 nt lds
    v_mfma_f32_16x16x32_bf16 a[108:111], v[140:143], v[192:195], a[108:111]
    v_exp_f32 v173, v173
    v_mfma_f32_16x16x32_bf16 a[112:115], v[144:147], v[192:195], a[112:115]
    v_exp_f32 v176, v176
    v_mfma_f32_16x16x32_bf16 a[116:119], v[148:151], v[192:195], a[116:119]
    v_exp_f32 v177, v177
    v_mfma_f32_16x16x32_bf16 a[120:123], v[152:155], v[192:195], a[120:123]
    v_mfma_f32_16x16x32_bf16 a[124:127], v[156:159], v[192:195], a[124:127]
    v_mfma_f32_16x16x32_bf16 v[236:239], v[12:15], v[192:195], v[236:239]
    s_add_u32 m0, s38, 1600
    v_mfma_f32_16x16x32_bf16 a[192:195], v[128:131], v[204:207], a[192:195]
    buffer_load_dwordx4 v6, s[12:15], s37 offen offset:512 nt lds
    v_mfma_f32_16x16x32_bf16 a[196:199], v[132:135], v[204:207], a[196:199]
    v_exp_f32 v178, v178
    v_mfma_f32_16x16x32_bf16 a[200:203], v[136:139], v[204:207], a[200:203]
    v_cvt_pk_bf16_f32 v200, v176, v177
    v_mfma_f32_16x16x32_bf16 a[204:207], v[140:143], v[204:207], a[204:207]
    v_mfma_f32_16x16x32_bf16 a[208:211], v[144:147], v[204:207], a[208:211]
    v_mfma_f32_16x16x32_bf16 a[212:215], v[148:151], v[204:207], a[212:215]
    v_exp_f32 v179, v179
    v_mfma_f32_16x16x32_bf16 a[216:219], v[152:155], v[204:207], a[216:219]
    v_add_u32 v3, s39, v5
    s_add_u32 s39, s39, 33792
    s_cmp_ge_u32 s39, 135168
    s_cselect_b32 s39, 0, s39
    v_mfma_f32_16x16x32_bf16 a[220:223], v[156:159], v[204:207], a[220:223]
    v_mfma_f32_16x16x32_bf16 v[248:251], v[12:15], v[204:207], v[248:251]
    s_cmp_lt_u32 s37, 286720
    s_cbranch_scc1 L_body0
    s_branch L_exit
L_body1:
    s_waitcnt lgkmcnt(0)
    v_mfma_f32_16x16x32_bf16 v[160:163], v[96:99], v[16:19], 0
    v_exp_f32 v174, v174
    v_mfma_f32_16x16x32_bf16 v[164:167], v[112:115], v[16:19], 0
    v_cvt_pk_bf16_f32 v198, v172, v173
    v_exp_f32 v180, v180
    v_mfma_f32_16x16x32_bf16 v[160:163], v[100:103], v[20:23], v[160:163]
    v_exp_f32 v175, v175
    v_mfma_f32_16x16x32_bf16 v[164:167], v[116:119], v[20:23], v[164:167]
    s_add_u32 m0, s38, 2400
    v_cvt_pk_bf16_f32 v201, v178, v179
    v_mfma_f32_16x16x32_bf16 v[160:163], v[104:107], v[24:27], v[160:163]
    buffer_load_dwordx4 v6, s[12:15], s37 offen offset:768 nt lds
    v_mfma_f32_16x16x32_bf16 v[164:167], v[120:123], v[24:27], v[164:167]
    v_cvt_pk_bf16_f32 v199, v174, v175
    v_mfma_f32_16x16x32_bf16 v[160:163], v[108:111], v[28:31], v[160:163]
    v_exp_f32 v181, v181
    v_mfma_f32_16x16x32_bf16 v[164:167], v[124:127], v[28:31], v[164:167]
    v_mfma_f32_16x16x32_bf16 a[128:131], v[128:131], v[196:199], a[128:131]
    v_mfma_f32_16x16x32_bf16 a[132:135], v[132:135], v[196:199], a[132:135]
    v_exp_f32 v182, v182
    v_mfma_f32_16x16x32_bf16 a[136:139], v[136:139], v[196:199], a[136:139]
    v_mfma_f32_16x16x32_bf16 a[140:143], v[140:143], v[196:199], a[140:143]
    s_nop 0
    v_exp_f32 v160, v160
    v_mfma_f32_16x16x32_bf16 a[144:147], v[144:147], v[196:199], a[144:147]
    v_cvt_pk_bf16_f32 v202, v180, v181
    v_mfma_f32_16x16x32_bf16 a[148:151], v[148:151], v[196:199], a[148:151]
    v_exp_f32 v161, v161
    v_mfma_f32_16x16x32_bf16 a[152:155], v[152:155], v[196:199], a[152:155]
    v_mfma_f32_16x16x32_bf16 a[156:159], v[156:159], v[196:199], a[156:159]
    v_exp_f32 v162, v162
    v_mfma_f32_16x16x32_bf16 v[240:243], v[12:15], v[196:199], v[240:243]
    s_add_u32 m0, s38, 3200
    v_mfma_f32_16x16x32_bf16 v[168:171], v[96:99], v[32:35], 0
    buffer_load_dwordx4 v6, s[12:15], s37 offen offset:1024 nt lds
    v_mfma_f32_16x16x32_bf16 v[172:175], v[112:115], v[32:35], 0
    v_exp_f32 v183, v183
    v_mfma_f32_16x16x32_bf16 v[168:171], v[100:103], v[36:39], v[168:171]
    v_cvt_pk_bf16_f32 v203, v182, v183
    v_cvt_pk_bf16_f32 v192, v160, v161
    v_mfma_f32_16x16x32_bf16 v[172:175], v[116:119], v[36:39], v[172:175]
    v_exp_f32 v163, v163
    v_mfma_f32_16x16x32_bf16 v[168:171], v[104:107], v[40:43], v[168:171]
    v_mfma_f32_16x16x32_bf16 v[172:175], v[120:123], v[40:43], v[172:175]
    v_exp_f32 v164, v164
    v_mfma_f32_16x16x32_bf16 v[168:171], v[108:111], v[44:47], v[168:171]
    v_mfma_f32_16x16x32_bf16 v[172:175], v[124:127], v[44:47], v[172:175]
    v_mfma_f32_16x16x32_bf16 a[160:163], v[128:131], v[200:203], a[160:163]
    ds_read_b64_tr_b16 v[128:129], v3 offset:0
    v_cvt_pk_bf16_f32 v193, v162, v163
    v_mfma_f32_16x16x32_bf16 a[164:167], v[132:135], v[200:203], a[164:167]
    ds_read_b64_tr_b16 v[130:131], v3 offset:512
    v_mfma_f32_16x16x32_bf16 a[168:171], v[136:139], v[200:203], a[168:171]
    ds_read_b64_tr_b16 v[132:133], v3 offset:32
    ds_read_b64_tr_b16 v[134:135], v3 offset:544
    v_mfma_f32_16x16x32_bf16 a[172:175], v[140:143], v[200:203], a[172:175]
    ds_read_b64_tr_b16 v[136:137], v3 offset:64
    ds_read_b64_tr_b16 v[138:139], v3 offset:576
    v_exp_f32 v165, v165
    v_mfma_f32_16x16x32_bf16 a[176:179], v[144:147], v[200:203], a[176:179]
    ds_read_b64_tr_b16 v[140:141], v3 offset:96
    ds_read_b64_tr_b16 v[142:143], v3 offset:608
    v_mfma_f32_16x16x32_bf16 a[180:183], v[148:151], v[200:203], a[180:183]
    ds_read_b64_tr_b16 v[144:145], v3 offset:128
    ds_read_b64_tr_b16 v[146:147], v3 offset:640
    v_exp_f32 v166, v166
    v_mfma_f32_16x16x32_bf16 a[184:187], v[152:155], v[200:203], a[184:187]
    ds_read_b64_tr_b16 v[148:149], v3 offset:160
    ds_read_b64_tr_b16 v[150:151], v3 offset:672
    v_mfma_f32_16x16x32_bf16 a[188:191], v[156:159], v[200:203], a[188:191]
    ds_read_b64_tr_b16 v[152:153], v3 offset:192
    ds_read_b64_tr_b16 v[154:155], v3 offset:704
    v_mfma_f32_16x16x32_bf16 v[244:247], v[12:15], v[200:203], v[244:247]
    ds_read_b64_tr_b16 v[156:157], v3 offset:224
    ds_read_b64_tr_b16 v[158:159], v3 offset:736
    v_mfma_f32_16x16x32_bf16 v[176:179], v[96:99], v[48:51], 0
    s_add_u32 m0, s38, 4000
    v_cvt_pk_bf16_f32 v194, v164, v165
    v_exp_f32 v168, v168
    v_mfma_f32_16x16x32_bf16 v[180:183], v[112:115], v[48:51], 0
    buffer_load_dwordx4 v6, s[12:15], s37 offen offset:1280 nt lds
    v_mfma_f32_16x16x32_bf16 v[176:179], v[100:103], v[52:55], v[176:179]
    v_exp_f32 v167, v167
    v_exp_f32 v169, v169
    v_mfma_f32_16x16x32_bf16 v[180:183], v[116:119], v[52:55], v[180:183]
    v_exp_f32 v170, v170
    v_mfma_f32_16x16x32_bf16 v[176:179], v[104:107], v[56:59], v[176:179]
    v_cvt_pk_bf16_f32 v195, v166, v167
    v_mfma_f32_16x16x32_bf16 v[180:183], v[120:123], v[56:59], v[180:183]
    v_cvt_pk_bf16_f32 v196, v168, v169
    v_mfma_f32_16x16x32_bf16 v[176:179], v[108:111], v[60:63], v[176:179]
    v_exp_f32 v171, v171
    v_mfma_f32_16x16x32_bf16 v[180:183], v[124:127], v[60:63], v[180:183]
    v_exp_f32 v172, v172
    v_mfma_f32_16x16x32_bf16 v[184:187], v[112:115], a[240:243], 0
    v_cvt_pk_bf16_f32 v197, v170, v171
    v_mfma_f32_16x16x32_bf16 v[184:187], v[116:119], a[244:247], v[184:187]
    v_mfma_f32_16x16x32_bf16 v[184:187], v[120:123], a[248:251], v[184:187]
    v_exp_f32 v173, v173
    v_mfma_f32_16x16x32_bf16 v[184:187], v[124:127], a[252:255], v[184:187]
    v_exp_f32 v174, v174
    s_waitcnt lgkmcnt(0)
    v_mfma_f32_16x16x32_bf16 a[0:3], v[128:131], v[192:195], a[0:3]
    v_mfma_f32_16x16x32_bf16 a[4:7], v[132:135], v[192:195], a[4:7]
    s_add_u32 m0, s38, 4800
    v_mfma_f32_16x16x32_bf16 a[8:11], v[136:139], v[192:195], a[8:11]
    buffer_load_dwordx4 v6, s[12:15], s37 offen offset:1536 nt lds
    v_mfma_f32_16x16x32_bf16 a[12:15], v[140:143], v[192:195], a[12:15]
    v_cvt_pk_bf16_f32 v198, v172, v173
    v_mfma_f32_16x16x32_bf16 a[16:19], v[144:147], v[192:195], a[16:19]
    v_exp_f32 v175, v175
    v_mfma_f32_16x16x32_bf16 a[20:23], v[148:151], v[192:195], a[20:23]
    v_cvt_pk_bf16_f32 v199, v174, v175
    v_mfma_f32_16x16x32_bf16 a[24:27], v[152:155], v[192:195], a[24:27]
    v_exp_f32 v176, v176
    v_mfma_f32_16x16x32_bf16 a[28:31], v[156:159], v[192:195], a[28:31]
    v_exp_f32 v177, v177
    v_mfma_f32_16x16x32_bf16 v[224:227], v[12:15], v[192:195], v[224:227]
    v_exp_f32 v178, v178
    v_mfma_f32_16x16x32_bf16 v[160:163], v[96:99], v[64:67], 0
    v_cvt_pk_bf16_f32 v200, v176, v177
    v_mfma_f32_16x16x32_bf16 v[164:167], v[112:115], v[64:67], 0
    v_exp_f32 v179, v179
    v_mfma_f32_16x16x32_bf16 v[160:163], v[100:103], v[68:71], v[160:163]
    v_exp_f32 v180, v180
    v_mfma_f32_16x16x32_bf16 v[164:167], v[116:119], v[68:71], v[164:167]
    v_cvt_pk_bf16_f32 v201, v178, v179
    v_mfma_f32_16x16x32_bf16 v[160:163], v[104:107], v[72:75], v[160:163]
    v_exp_f32 v181, v181
    v_exp_f32 v184, v184
    v_mfma_f32_16x16x32_bf16 v[164:167], v[120:123], v[72:75], v[164:167]
    v_exp_f32 v182, v182
    v_mfma_f32_16x16x32_bf16 v[160:163], v[108:111], v[76:79], v[160:163]
    v_exp_f32 v185, v185
    v_mfma_f32_16x16x32_bf16 v[164:167], v[124:127], v[76:79], v[164:167]
    s_add_u32 m0, s38, 5600
    v_mfma_f32_16x16x32_bf16 a[32:35], v[128:131], v[196:199], a[32:35]
    buffer_load_dwordx4 v6, s[12:15], s37 offen offset:1792 nt lds
    v_mfma_f32_16x16x32_bf16 a[36:39], v[132:135], v[196:199], a[36:39]
    v_cvt_pk_bf16_f32 v202, v180, v181
    v_exp_f32 v186, v186
    v_mfma_f32_16x16x32_bf16 a[40:43], v[136:139], v[196:199], a[40:43]
    v_exp_f32 v183, v183
    v_mfma_f32_16x16x32_bf16 a[44:47], v[140:143], v[196:199], a[44:47]
    v_cvt_pk_bf16_f32 v203, v182, v183
    v_mfma_f32_16x16x32_bf16 a[48:51], v[144:147], v[196:199], a[48:51]
    v_cvt_pk_bf16_f32 v206, v184, v185
    v_mfma_f32_16x16x32_bf16 a[52:55], v[148:151], v[196:199], a[52:55]
    v_exp_f32 v187, v187
    v_mfma_f32_16x16x32_bf16 a[56:59], v[152:155], v[196:199], a[56:59]
    v_exp_f32 v160, v160
    v_mfma_f32_16x16x32_bf16 a[60:63], v[156:159], v[196:199], a[60:63]
    v_cvt_pk_bf16_f32 v207, v186, v187
    v_exp_f32 v161, v161
    v_mfma_f32_16x16x32_bf16 v[228:231], v[12:15], v[196:199], v[228:231]
    v_exp_f32 v162, v162
    v_mfma_f32_16x16x32_bf16 v[168:171], v[96:99], v[80:83], 0
    v_cvt_pk_bf16_f32 v192, v160, v161
    v_mfma_f32_16x16x32_bf16 v[172:175], v[112:115], v[80:83], 0
    v_exp_f32 v163, v163
    v_mfma_f32_16x16x32_bf16 v[168:171], v[100:103], v[84:87], v[168:171]
    v_mfma_f32_16x16x32_bf16 v[172:175], v[116:119], v[84:87], v[172:175]
    v_exp_f32 v164, v164
    v_mfma_f32_16x16x32_bf16 v[168:171], v[104:107], v[88:91], v[168:171]
    v_mfma_f32_16x16x32_bf16 v[172:175], v[120:123], v[88:91], v[172:175]
    v_cvt_pk_bf16_f32 v193, v162, v163
    v_mfma_f32_16x16x32_bf16 v[168:171], v[108:111], v[92:95], v[168:171]
    v_exp_f32 v165, v165
    v_mfma_f32_16x16x32_bf16 v[172:175], v[124:127], v[92:95], v[172:175]
    v_mfma_f32_16x16x32_bf16 a[64:67], v[128:131], v[200:203], a[64:67]
    v_exp_f32 v166, v166
    v_mfma_f32_16x16x32_bf16 a[68:71], v[132:135], v[200:203], a[68:71]
    v_mfma_f32_16x16x32_bf16 a[72:75], v[136:139], v[200:203], a[72:75]
    v_cvt_pk_bf16_f32 v194, v164, v165
    v_add_u32 v2, s39, v4
    v_mfma_f32_16x16x32_bf16 a[76:79], v[140:143], v[200:203], a[76:79]
    v_exp_f32 v167, v167
    v_mfma_f32_16x16x32_bf16 a[80:83], v[144:147], v[200:203], a[80:83]
    v_mfma_f32_16x16x32_bf16 a[84:87], v[148:151], v[200:203], a[84:87]
    v_cvt_pk_bf16_f32 v195, v166, v167
    v_mfma_f32_16x16x32_bf16 a[88:91], v[152:155], v[200:203], a[88:91]
    v_mfma_f32_16x16x32_bf16 a[92:95], v[156:159], v[200:203], a[92:95]
    v_exp_f32 v168, v168
    v_mfma_f32_16x16x32_bf16 v[232:235], v[12:15], v[200:203], v[232:235]
    v_exp_f32 v169, v169
    s_waitcnt vmcnt(16) lgkmcnt(0)
    s_barrier
    s_add_u32 s37, s37, 8192
        s_add_u32 s38, s38, 33792
        s_cmp_ge_u32 s38, s42
        s_cselect_b32 s38, s41, s38
    v_exp_f32 v170, v170
    v_mfma_f32_16x16x32_bf16 v[176:179], v[96:99], a[224:227], 0
    ds_read_b128 v[96:99], v2 offset:0
    v_mfma_f32_16x16x32_bf16 v[180:183], v[112:115], a[224:227], 0
    ds_read_b128 v[112:115], v2 offset:512
    s_add_u32 m0, s38, 0
    v_mfma_f32_16x16x32_bf16 v[176:179], v[100:103], a[228:231], v[176:179]
    ds_read_b128 v[100:103], v2 offset:64
    buffer_load_dwordx4 v6, s[12:15], s37 offen offset:0 nt lds
    v_mfma_f32_16x16x32_bf16 v[180:183], v[116:119], a[228:231], v[180:183]
    ds_read_b128 v[116:119], v2 offset:576
    v_cvt_pk_bf16_f32 v196, v168, v169
    v_mfma_f32_16x16x32_bf16 v[176:179], v[104:107], a[232:235], v[176:179]
    ds_read_b128 v[104:107], v2 offset:128
    v_exp_f32 v171, v171
    v_mfma_f32_16x16x32_bf16 v[180:183], v[120:123], a[232:235], v[180:183]
    ds_read_b128 v[120:123], v2 offset:640
    v_exp_f32 v172, v172
    v_mfma_f32_16x16x32_bf16 v[176:179], v[108:111], a[236:239], v[176:179]
    ds_read_b128 v[108:111], v2 offset:192
    v_mfma_f32_16x16x32_bf16 v[180:183], v[124:127], a[236:239], v[180:183]
    ds_read_b128 v[124:127], v2 offset:704
    v_mfma_f32_16x16x32_bf16 a[96:99], v[128:131], v[192:195], a[96:99]
    v_cvt_pk_bf16_f32 v197, v170, v171
    v_mfma_f32_16x16x32_bf16 a[100:103], v[132:135], v[192:195], a[100:103]
    s_add_u32 m0, s38, 800
    v_mfma_f32_16x16x32_bf16 a[104:107], v[136:139], v[192:195], a[104:107]
    buffer_load_dwordx4 v6, s[12:15], s37 offen offset:256 nt lds
    v_mfma_f32_16x16x32_bf16 a[108:111], v[140:143], v[192:195], a[108:111]
    v_exp_f32 v173, v173
    v_mfma_f32_16x16x32_bf16 a[112:115], v[144:147], v[192:195], a[112:115]
    v_exp_f32 v176, v176
    v_mfma_f32_16x16x32_bf16 a[116:119], v[148:151], v[192:195], a[116:119]
    v_exp_f32 v177, v177
    v_mfma_f32_16x16x32_bf16 a[120:123], v[152:155], v[192:195], a[120:123]
    v_mfma_f32_16x16x32_bf16 a[124:127], v[156:159], v[192:195], a[124:127]
    v_mfma_f32_16x16x32_bf16 v[236:239], v[12:15], v[192:195], v[236:239]
    s_add_u32 m0, s38, 1600
    v_mfma_f32_16x16x32_bf16 a[192:195], v[128:131], v[204:207], a[192:195]
    buffer_load_dwordx4 v6, s[12:15], s37 offen offset:512 nt lds
    v_mfma_f32_16x16x32_bf16 a[196:199], v[132:135], v[204:207], a[196:199]
    v_exp_f32 v178, v178
    v_mfma_f32_16x16x32_bf16 a[200:203], v[136:139], v[204:207], a[200:203]
    v_cvt_pk_bf16_f32 v200, v176, v177
    v_mfma_f32_16x16x32_bf16 a[204:207], v[140:143], v[204:207], a[204:207]
    v_mfma_f32_16x16x32_bf16 a[208:211], v[144:147], v[204:207], a[208:211]
    v_mfma_f32_16x16x32_bf16 a[212:215], v[148:151], v[204:207], a[212:215]
    v_exp_f32 v179, v179
    v_mfma_f32_16x16x32_bf16 a[216:219], v[152:155], v[204:207], a[216:219]
    v_add_u32 v3, s39, v5
    s_add_u32 s39, s39, 33792
    s_cmp_ge_u32 s39, 135168
    s_cselect_b32 s39, 0, s39
    v_mfma_f32_16x16x32_bf16 a[220:223], v[156:159], v[204:207], a[220:223]
    v_mfma_f32_16x16x32_bf16 v[248:251], v[12:15], v[204:207], v[248:251]
    s_cmp_lt_u32 s37, 286720
    s_cbranch_scc1 L_body1
L_exit:
    s_nop 7
    v_exp_f32 v174, v174
    v_cvt_pk_bf16_f32 v198, v172, v173
    v_exp_f32 v175, v175
    s_nop 0
    v_cvt_pk_bf16_f32 v199, v174, v175
    s_nop 1
    v_mfma_f32_16x16x32_bf16 a[128:131], v[128:131], v[196:199], a[128:131]
    v_exp_f32 v180, v180
    v_mfma_f32_16x16x32_bf16 a[132:135], v[132:135], v[196:199], a[132:135]
    v_cvt_pk_bf16_f32 v201, v178, v179
    v_mfma_f32_16x16x32_bf16 a[136:139], v[136:139], v[196:199], a[136:139]
    v_exp_f32 v181, v181
    v_mfma_f32_16x16x32_bf16 a[140:143], v[140:143], v[196:199], a[140:143]
    v_exp_f32 v182, v182
    v_mfma_f32_16x16x32_bf16 a[144:147], v[144:147], v[196:199], a[144:147]
    v_cvt_pk_bf16_f32 v202, v180, v181
    v_mfma_f32_16x16x32_bf16 a[148:151], v[148:151], v[196:199], a[148:151]
    v_exp_f32 v183, v183
    v_mfma_f32_16x16x32_bf16 a[152:155], v[152:155], v[196:199], a[152:155]
    v_cvt_pk_bf16_f32 v203, v182, v183
    v_mfma_f32_16x16x32_bf16 a[156:159], v[156:159], v[196:199], a[156:159]
    v_mfma_f32_16x16x32_bf16 v[240:243], v[12:15], v[196:199], v[240:243]
    v_mfma_f32_16x16x32_bf16 a[160:163], v[128:131], v[200:203], a[160:163]
    v_mfma_f32_16x16x32_bf16 a[164:167], v[132:135], v[200:203], a[164:167]
    v_mfma_f32_16x16x32_bf16 a[168:171], v[136:139], v[200:203], a[168:171]
    v_mfma_f32_16x16x32_bf16 a[172:175], v[140:143], v[200:203], a[172:175]
    v_mfma_f32_16x16x32_bf16 a[176:179], v[144:147], v[200:203], a[176:179]
    v_mfma_f32_16x16x32_bf16 a[180:183], v[148:151], v[200:203], a[180:183]
    v_mfma_f32_16x16x32_bf16 a[184:187], v[152:155], v[200:203], a[184:187]
    v_mfma_f32_16x16x32_bf16 a[188:191], v[156:159], v[200:203], a[188:191]
    v_mfma_f32_16x16x32_bf16 v[244:247], v[12:15], v[200:203], v[244:247]
    s_mov_b64 s[56:57], 0
    s_mov_b32 s58, 0x5d800000
    s_mov_b32 s60, 0x21800000
    v_cmp_nge_f32 vcc, s58, v224
    s_nop 0
    s_or_b64 s[56:57], s[56:57], vcc
    v_cmp_nle_f32 vcc, s60, v224
    s_nop 0
    s_or_b64 s[56:57], s[56:57], vcc
    v_cmp_nge_f32 vcc, s58, v228
    s_nop 0
    s_or_b64 s[56:57], s[56:57], vcc
    v_cmp_nle_f32 vcc, s60, v228
    s_nop 0
    s_or_b64 s[56:57], s[56:57], vcc
    v_cmp_nge_f32 vcc, s58, v232
    s_nop 0
    s_or_b64 s[56:57], s[56:57], vcc
    v_cmp_nle_f32 vcc, s60, v232
    s_nop 0
    s_or_b64 s[56:57], s[56:57], vcc
    v_cmp_nge_f32 vcc, s58, v236
    s_nop 0
    s_or_b64 s[56:57], s[56:57], vcc
    v_cmp_nle_f32 vcc, s60, v236
    s_nop 0
    s_or_b64 s[56:57], s[56:57], vcc
    v_cmp_nge_f32 vcc, s58, v240
    s_nop 0
    s_or_b64 s[56:57], s[56:57], vcc
    v_cmp_nle_f32 vcc, s60, v240
    s_nop 0
    s_or_b64 s[56:57], s[56:57], vcc
    v_cmp_nge_f32 vcc, s58, v244
    s_nop 0
    s_or_b64 s[56:57], s[56:57], vcc
    v_cmp_nle_f32 vcc, s60, v244
    s_nop 0
    s_or_b64 s[56:57], s[56:57], vcc
    v_cmp_nge_f32 vcc, s58, v248
    s_nop 0
    s_or_b64 s[56:57], s[56:57], vcc
    v_cmp_nle_f32 vcc, s60, v248
    s_nop 0
    s_or_b64 s[56:57], s[56:57], vcc
    s_cmp_lg_u64 s[56:57], 0
    s_cselect_b32 s58, 1, 0
    s_lshl_b32 s10, s3, 2
    s_add_u32 s10, s10, 135168
    v_mov_b32 v160, s58
    v_mov_b32 v161, s10
    v_mov_b32 v162, 135168
    ds_write_b32 v161, v160
    s_waitcnt vmcnt(0) lgkmcnt(0)
    s_barrier
    ds_read_b128 v[164:167], v162
    s_waitcnt lgkmcnt(0)
    v_or_b32 v164, v164, v165
    v_or3_b32 v164, v164, v166, v167
    s_nop 0
    v_readfirstlane_b32 s58, v164
    s_nop 1
    s_cmp_lg_u32 s58, 0
    s_cbranch_scc1 L_fallback
L_epi:
    v_add_u32 v12, s51, v11
    v_lshlrev_b32 v13, 2, v1
    v_add_u32 v13, s51, v13
    ds_write_b128 v12, a[192:195] offset:0
    ds_write_b128 v12, a[196:199] offset:1024
    ds_write_b128 v12, a[200:203] offset:2048
    ds_write_b128 v12, a[204:207] offset:3072
    ds_write_b128 v12, a[208:211] offset:4096
    ds_write_b128 v12, a[212:215] offset:5120
    ds_write_b128 v12, a[216:219] offset:6144
    ds_write_b128 v12, a[220:223] offset:7168
    ds_write_b32 v13, v248 offset:8192
    s_mul_i32 s10, s5, 24576
    v_add_u32 v14, s10, v11
    v_rcp_f32 v200, v224
    v_rcp_f32 v201, v224
    v_rcp_f32 v202, v228
    v_rcp_f32 v203, v228
    v_rcp_f32 v204, v232
    v_rcp_f32 v205, v232
    v_rcp_f32 v206, v236
    v_rcp_f32 v207, v236
    v_rcp_f32 v208, v240
    v_rcp_f32 v209, v240
    v_rcp_f32 v210, v244
    v_rcp_f32 v211, v244
    v_accvgpr_read_b32 v96, a0
    v_accvgpr_read_b32 v97, a1
    v_accvgpr_read_b32 v98, a2
    v_accvgpr_read_b32 v99, a3
    v_accvgpr_read_b32 v100, a4
    v_accvgpr_read_b32 v101, a5
    v_accvgpr_read_b32 v102, a6
    v_accvgpr_read_b32 v103, a7
    v_pk_mul_f32 v[96:97], v[96:97], v[200:201]
    v_pk_mul_f32 v[98:99], v[98:99], v[200:201]
    v_pk_mul_f32 v[100:101], v[100:101], v[200:201]
    v_pk_mul_f32 v[102:103], v[102:103], v[200:201]
    v_cvt_pk_bf16_f32 v104, v96, v97
    v_cvt_pk_bf16_f32 v105, v98, v99
    v_cvt_pk_bf16_f32 v106, v100, v101
    v_cvt_pk_bf16_f32 v107, v102, v103
    s_movk_i32 s11, 0
    buffer_store_dwordx4 v[104:107], v14, s[24:27], s11 offen sc1
    v_accvgpr_read_b32 v108, a8
    v_accvgpr_read_b32 v109, a9
    v_accvgpr_read_b32 v110, a10
    v_accvgpr_read_b32 v111, a11
    v_accvgpr_read_b32 v112, a12
    v_accvgpr_read_b32 v113, a13
    v_accvgpr_read_b32 v114, a14
    v_accvgpr_read_b32 v115, a15
    v_pk_mul_f32 v[108:109], v[108:109], v[200:201]
    v_pk_mul_f32 v[110:111], v[110:111], v[200:201]
    v_pk_mul_f32 v[112:113], v[112:113], v[200:201]
    v_pk_mul_f32 v[114:115], v[114:115], v[200:201]
    v_cvt_pk_bf16_f32 v116, v108, v109
    v_cvt_pk_bf16_f32 v117, v110, v111
    v_cvt_pk_bf16_f32 v118, v112, v113
    v_cvt_pk_bf16_f32 v119, v114, v115
    s_movk_i32 s11, 1024
    buffer_store_dwordx4 v[116:119], v14, s[24:27], s11 offen sc1
    v_accvgpr_read_b32 v120, a16
    v_accvgpr_read_b32 v121, a17
    v_accvgpr_read_b32 v122, a18
    v_accvgpr_read_b32 v123, a19
    v_accvgpr_read_b32 v124, a20
    v_accvgpr_read_b32 v125, a21
    v_accvgpr_read_b32 v126, a22
    v_accvgpr_read_b32 v127, a23
    v_pk_mul_f32 v[120:121], v[120:121], v[200:201]
    v_pk_mul_f32 v[122:123], v[122:123], v[200:201]
    v_pk_mul_f32 v[124:125], v[124:125], v[200:201]
    v_pk_mul_f32 v[126:127], v[126:127], v[200:201]
    v_cvt_pk_bf16_f32 v128, v120, v121
    v_cvt_pk_bf16_f32 v129, v122, v123
    v_cvt_pk_bf16_f32 v130, v124, v125
    v_cvt_pk_bf16_f32 v131, v126, v127
    s_movk_i32 s11, 2048
    buffer_store_dwordx4 v[128:131], v14, s[24:27], s11 offen sc1
    v_accvgpr_read_b32 v132, a24
    v_accvgpr_read_b32 v133, a25
    v_accvgpr_read_b32 v134, a26
    v_accvgpr_read_b32 v135, a27
    v_accvgpr_read_b32 v136, a28
    v_accvgpr_read_b32 v137, a29
    v_accvgpr_read_b32 v138, a30
    v_accvgpr_read_b32 v139, a31
    v_pk_mul_f32 v[132:133], v[132:133], v[200:201]
    v_pk_mul_f32 v[134:135], v[134:135], v[200:201]
    v_pk_mul_f32 v[136:137], v[136:137], v[200:201]
    v_pk_mul_f32 v[138:139], v[138:139], v[200:201]
    v_cvt_pk_bf16_f32 v140, v132, v133
    v_cvt_pk_bf16_f32 v141, v134, v135
    v_cvt_pk_bf16_f32 v142, v136, v137
    v_cvt_pk_bf16_f32 v143, v138, v139
    s_movk_i32 s11, 3072
    buffer_store_dwordx4 v[140:143], v14, s[24:27], s11 offen sc1
    v_accvgpr_read_b32 v96, a32
    v_accvgpr_read_b32 v97, a33
    v_accvgpr_read_b32 v98, a34
    v_accvgpr_read_b32 v99, a35
    v_accvgpr_read_b32 v100, a36
    v_accvgpr_read_b32 v101, a37
    v_accvgpr_read_b32 v102, a38
    v_accvgpr_read_b32 v103, a39
    v_pk_mul_f32 v[96:97], v[96:97], v[202:203]
    v_pk_mul_f32 v[98:99], v[98:99], v[202:203]
    v_pk_mul_f32 v[100:101], v[100:101], v[202:203]
    v_pk_mul_f32 v[102:103], v[102:103], v[202:203]
    v_cvt_pk_bf16_f32 v104, v96, v97
    v_cvt_pk_bf16_f32 v105, v98, v99
    v_cvt_pk_bf16_f32 v106, v100, v101
    v_cvt_pk_bf16_f32 v107, v102, v103
    s_movk_i32 s11, 4096
    buffer_store_dwordx4 v[104:107], v14, s[24:27], s11 offen sc1
    v_accvgpr_read_b32 v108, a40
    v_accvgpr_read_b32 v109, a41
    v_accvgpr_read_b32 v110, a42
    v_accvgpr_read_b32 v111, a43
    v_accvgpr_read_b32 v112, a44
    v_accvgpr_read_b32 v113, a45
    v_accvgpr_read_b32 v114, a46
    v_accvgpr_read_b32 v115, a47
    v_pk_mul_f32 v[108:109], v[108:109], v[202:203]
    v_pk_mul_f32 v[110:111], v[110:111], v[202:203]
    v_pk_mul_f32 v[112:113], v[112:113], v[202:203]
    v_pk_mul_f32 v[114:115], v[114:115], v[202:203]
    v_cvt_pk_bf16_f32 v116, v108, v109
    v_cvt_pk_bf16_f32 v117, v110, v111
    v_cvt_pk_bf16_f32 v118, v112, v113
    v_cvt_pk_bf16_f32 v119, v114, v115
    s_movk_i32 s11, 5120
    buffer_store_dwordx4 v[116:119], v14, s[24:27], s11 offen sc1
    v_accvgpr_read_b32 v120, a48
    v_accvgpr_read_b32 v121, a49
    v_accvgpr_read_b32 v122, a50
    v_accvgpr_read_b32 v123, a51
    v_accvgpr_read_b32 v124, a52
    v_accvgpr_read_b32 v125, a53
    v_accvgpr_read_b32 v126, a54
    v_accvgpr_read_b32 v127, a55
    v_pk_mul_f32 v[120:121], v[120:121], v[202:203]
    v_pk_mul_f32 v[122:123], v[122:123], v[202:203]
    v_pk_mul_f32 v[124:125], v[124:125], v[202:203]
    v_pk_mul_f32 v[126:127], v[126:127], v[202:203]
    v_cvt_pk_bf16_f32 v128, v120, v121
    v_cvt_pk_bf16_f32 v129, v122, v123
    v_cvt_pk_bf16_f32 v130, v124, v125
    v_cvt_pk_bf16_f32 v131, v126, v127
    s_movk_i32 s11, 6144
    buffer_store_dwordx4 v[128:131], v14, s[24:27], s11 offen sc1
    v_accvgpr_read_b32 v132, a56
    v_accvgpr_read_b32 v133, a57
    v_accvgpr_read_b32 v134, a58
    v_accvgpr_read_b32 v135, a59
    v_accvgpr_read_b32 v136, a60
    v_accvgpr_read_b32 v137, a61
    v_accvgpr_read_b32 v138, a62
    v_accvgpr_read_b32 v139, a63
    v_pk_mul_f32 v[132:133], v[132:133], v[202:203]
    v_pk_mul_f32 v[134:135], v[134:135], v[202:203]
    v_pk_mul_f32 v[136:137], v[136:137], v[202:203]
    v_pk_mul_f32 v[138:139], v[138:139], v[202:203]
    v_cvt_pk_bf16_f32 v140, v132, v133
    v_cvt_pk_bf16_f32 v141, v134, v135
    v_cvt_pk_bf16_f32 v142, v136, v137
    v_cvt_pk_bf16_f32 v143, v138, v139
    s_movk_i32 s11, 7168
    buffer_store_dwordx4 v[140:143], v14, s[24:27], s11 offen sc1
    s_waitcnt lgkmcnt(0)
    s_barrier
    s_mul_i32 s10, s4, 16896
    s_lshl_b32 s11, s5, 12
    s_add_u32 s11, s11, s10
    v_add_u32 v12, s11, v11
    v_lshlrev_b32 v13, 2, v1
    v_add_u32 v13, s10, v13
    ds_read_b128 v[160:163], v12 offset:0
    ds_read_b128 v[164:167], v12 offset:1024
    ds_read_b128 v[168:171], v12 offset:2048
    ds_read_b128 v[172:175], v12 offset:3072
    ds_read_b32 v192, v13 offset:8192
    ds_read_b128 v[176:179], v12 offset:8448
    ds_read_b128 v[180:183], v12 offset:9472
    ds_read_b128 v[184:187], v12 offset:10496
    ds_read_b128 v[188:191], v12 offset:11520
    ds_read_b32 v193, v13 offset:16640
    v_accvgpr_read_b32 v96, a64
    v_accvgpr_read_b32 v97, a65
    v_accvgpr_read_b32 v98, a66
    v_accvgpr_read_b32 v99, a67
    v_accvgpr_read_b32 v100, a68
    v_accvgpr_read_b32 v101, a69
    v_accvgpr_read_b32 v102, a70
    v_accvgpr_read_b32 v103, a71
    v_pk_mul_f32 v[96:97], v[96:97], v[204:205]
    v_pk_mul_f32 v[98:99], v[98:99], v[204:205]
    v_pk_mul_f32 v[100:101], v[100:101], v[204:205]
    v_pk_mul_f32 v[102:103], v[102:103], v[204:205]
    v_cvt_pk_bf16_f32 v104, v96, v97
    v_cvt_pk_bf16_f32 v105, v98, v99
    v_cvt_pk_bf16_f32 v106, v100, v101
    v_cvt_pk_bf16_f32 v107, v102, v103
    s_movk_i32 s11, 8192
    buffer_store_dwordx4 v[104:107], v14, s[24:27], s11 offen sc1
    v_accvgpr_read_b32 v108, a72
    v_accvgpr_read_b32 v109, a73
    v_accvgpr_read_b32 v110, a74
    v_accvgpr_read_b32 v111, a75
    v_accvgpr_read_b32 v112, a76
    v_accvgpr_read_b32 v113, a77
    v_accvgpr_read_b32 v114, a78
    v_accvgpr_read_b32 v115, a79
    v_pk_mul_f32 v[108:109], v[108:109], v[204:205]
    v_pk_mul_f32 v[110:111], v[110:111], v[204:205]
    v_pk_mul_f32 v[112:113], v[112:113], v[204:205]
    v_pk_mul_f32 v[114:115], v[114:115], v[204:205]
    v_cvt_pk_bf16_f32 v116, v108, v109
    v_cvt_pk_bf16_f32 v117, v110, v111
    v_cvt_pk_bf16_f32 v118, v112, v113
    v_cvt_pk_bf16_f32 v119, v114, v115
    s_movk_i32 s11, 9216
    buffer_store_dwordx4 v[116:119], v14, s[24:27], s11 offen sc1
    v_accvgpr_read_b32 v120, a80
    v_accvgpr_read_b32 v121, a81
    v_accvgpr_read_b32 v122, a82
    v_accvgpr_read_b32 v123, a83
    v_accvgpr_read_b32 v124, a84
    v_accvgpr_read_b32 v125, a85
    v_accvgpr_read_b32 v126, a86
    v_accvgpr_read_b32 v127, a87
    v_pk_mul_f32 v[120:121], v[120:121], v[204:205]
    v_pk_mul_f32 v[122:123], v[122:123], v[204:205]
    v_pk_mul_f32 v[124:125], v[124:125], v[204:205]
    v_pk_mul_f32 v[126:127], v[126:127], v[204:205]
    v_cvt_pk_bf16_f32 v128, v120, v121
    v_cvt_pk_bf16_f32 v129, v122, v123
    v_cvt_pk_bf16_f32 v130, v124, v125
    v_cvt_pk_bf16_f32 v131, v126, v127
    s_movk_i32 s11, 10240
    buffer_store_dwordx4 v[128:131], v14, s[24:27], s11 offen sc1
    v_accvgpr_read_b32 v132, a88
    v_accvgpr_read_b32 v133, a89
    v_accvgpr_read_b32 v134, a90
    v_accvgpr_read_b32 v135, a91
    v_accvgpr_read_b32 v136, a92
    v_accvgpr_read_b32 v137, a93
    v_accvgpr_read_b32 v138, a94
    v_accvgpr_read_b32 v139, a95
    v_pk_mul_f32 v[132:133], v[132:133], v[204:205]
    v_pk_mul_f32 v[134:135], v[134:135], v[204:205]
    v_pk_mul_f32 v[136:137], v[136:137], v[204:205]
    v_pk_mul_f32 v[138:139], v[138:139], v[204:205]
    v_cvt_pk_bf16_f32 v140, v132, v133
    v_cvt_pk_bf16_f32 v141, v134, v135
    v_cvt_pk_bf16_f32 v142, v136, v137
    v_cvt_pk_bf16_f32 v143, v138, v139
    s_movk_i32 s11, 11264
    buffer_store_dwordx4 v[140:143], v14, s[24:27], s11 offen sc1
    v_accvgpr_read_b32 v96, a96
    v_accvgpr_read_b32 v97, a97
    v_accvgpr_read_b32 v98, a98
    v_accvgpr_read_b32 v99, a99
    v_accvgpr_read_b32 v100, a100
    v_accvgpr_read_b32 v101, a101
    v_accvgpr_read_b32 v102, a102
    v_accvgpr_read_b32 v103, a103
    v_pk_mul_f32 v[96:97], v[96:97], v[206:207]
    v_pk_mul_f32 v[98:99], v[98:99], v[206:207]
    v_pk_mul_f32 v[100:101], v[100:101], v[206:207]
    v_pk_mul_f32 v[102:103], v[102:103], v[206:207]
    v_cvt_pk_bf16_f32 v104, v96, v97
    v_cvt_pk_bf16_f32 v105, v98, v99
    v_cvt_pk_bf16_f32 v106, v100, v101
    v_cvt_pk_bf16_f32 v107, v102, v103
    s_movk_i32 s11, 12288
    buffer_store_dwordx4 v[104:107], v14, s[24:27], s11 offen sc1
    v_accvgpr_read_b32 v108, a104
    v_accvgpr_read_b32 v109, a105
    v_accvgpr_read_b32 v110, a106
    v_accvgpr_read_b32 v111, a107
    v_accvgpr_read_b32 v112, a108
    v_accvgpr_read_b32 v113, a109
    v_accvgpr_read_b32 v114, a110
    v_accvgpr_read_b32 v115, a111
    v_pk_mul_f32 v[108:109], v[108:109], v[206:207]
    v_pk_mul_f32 v[110:111], v[110:111], v[206:207]
    v_pk_mul_f32 v[112:113], v[112:113], v[206:207]
    v_pk_mul_f32 v[114:115], v[114:115], v[206:207]
    v_cvt_pk_bf16_f32 v116, v108, v109
    v_cvt_pk_bf16_f32 v117, v110, v111
    v_cvt_pk_bf16_f32 v118, v112, v113
    v_cvt_pk_bf16_f32 v119, v114, v115
    s_movk_i32 s11, 13312
    buffer_store_dwordx4 v[116:119], v14, s[24:27], s11 offen sc1
    v_accvgpr_read_b32 v120, a112
    v_accvgpr_read_b32 v121, a113
    v_accvgpr_read_b32 v122, a114
    v_accvgpr_read_b32 v123, a115
    v_accvgpr_read_b32 v124, a116
    v_accvgpr_read_b32 v125, a117
    v_accvgpr_read_b32 v126, a118
    v_accvgpr_read_b32 v127, a119
    v_pk_mul_f32 v[120:121], v[120:121], v[206:207]
    v_pk_mul_f32 v[122:123], v[122:123], v[206:207]
    v_pk_mul_f32 v[124:125], v[124:125], v[206:207]
    v_pk_mul_f32 v[126:127], v[126:127], v[206:207]
    v_cvt_pk_bf16_f32 v128, v120, v121
    v_cvt_pk_bf16_f32 v129, v122, v123
    v_cvt_pk_bf16_f32 v130, v124, v125
    v_cvt_pk_bf16_f32 v131, v126, v127
    s_movk_i32 s11, 14336
    buffer_store_dwordx4 v[128:131], v14, s[24:27], s11 offen sc1
    v_accvgpr_read_b32 v132, a120
    v_accvgpr_read_b32 v133, a121
    v_accvgpr_read_b32 v134, a122
    v_accvgpr_read_b32 v135, a123
    v_accvgpr_read_b32 v136, a124
    v_accvgpr_read_b32 v137, a125
    v_accvgpr_read_b32 v138, a126
    v_accvgpr_read_b32 v139, a127
    v_pk_mul_f32 v[132:133], v[132:133], v[206:207]
    v_pk_mul_f32 v[134:135], v[134:135], v[206:207]
    v_pk_mul_f32 v[136:137], v[136:137], v[206:207]
    v_pk_mul_f32 v[138:139], v[138:139], v[206:207]
    v_cvt_pk_bf16_f32 v140, v132, v133
    v_cvt_pk_bf16_f32 v141, v134, v135
    v_cvt_pk_bf16_f32 v142, v136, v137
    v_cvt_pk_bf16_f32 v143, v138, v139
    s_movk_i32 s11, 15360
    buffer_store_dwordx4 v[140:143], v14, s[24:27], s11 offen sc1
    v_accvgpr_read_b32 v96, a128
    v_accvgpr_read_b32 v97, a129
    v_accvgpr_read_b32 v98, a130
    v_accvgpr_read_b32 v99, a131
    v_accvgpr_read_b32 v100, a132
    v_accvgpr_read_b32 v101, a133
    v_accvgpr_read_b32 v102, a134
    v_accvgpr_read_b32 v103, a135
    v_pk_mul_f32 v[96:97], v[96:97], v[208:209]
    v_pk_mul_f32 v[98:99], v[98:99], v[208:209]
    v_pk_mul_f32 v[100:101], v[100:101], v[208:209]
    v_pk_mul_f32 v[102:103], v[102:103], v[208:209]
    v_cvt_pk_bf16_f32 v104, v96, v97
    v_cvt_pk_bf16_f32 v105, v98, v99
    v_cvt_pk_bf16_f32 v106, v100, v101
    v_cvt_pk_bf16_f32 v107, v102, v103
    s_movk_i32 s11, 16384
    buffer_store_dwordx4 v[104:107], v14, s[24:27], s11 offen sc1
    v_accvgpr_read_b32 v108, a136
    v_accvgpr_read_b32 v109, a137
    v_accvgpr_read_b32 v110, a138
    v_accvgpr_read_b32 v111, a139
    v_accvgpr_read_b32 v112, a140
    v_accvgpr_read_b32 v113, a141
    v_accvgpr_read_b32 v114, a142
    v_accvgpr_read_b32 v115, a143
    v_pk_mul_f32 v[108:109], v[108:109], v[208:209]
    v_pk_mul_f32 v[110:111], v[110:111], v[208:209]
    v_pk_mul_f32 v[112:113], v[112:113], v[208:209]
    v_pk_mul_f32 v[114:115], v[114:115], v[208:209]
    v_cvt_pk_bf16_f32 v116, v108, v109
    v_cvt_pk_bf16_f32 v117, v110, v111
    v_cvt_pk_bf16_f32 v118, v112, v113
    v_cvt_pk_bf16_f32 v119, v114, v115
    s_movk_i32 s11, 17408
    buffer_store_dwordx4 v[116:119], v14, s[24:27], s11 offen sc1
    v_accvgpr_read_b32 v120, a144
    v_accvgpr_read_b32 v121, a145
    v_accvgpr_read_b32 v122, a146
    v_accvgpr_read_b32 v123, a147
    v_accvgpr_read_b32 v124, a148
    v_accvgpr_read_b32 v125, a149
    v_accvgpr_read_b32 v126, a150
    v_accvgpr_read_b32 v127, a151
    v_pk_mul_f32 v[120:121], v[120:121], v[208:209]
    v_pk_mul_f32 v[122:123], v[122:123], v[208:209]
    v_pk_mul_f32 v[124:125], v[124:125], v[208:209]
    v_pk_mul_f32 v[126:127], v[126:127], v[208:209]
    v_cvt_pk_bf16_f32 v128, v120, v121
    v_cvt_pk_bf16_f32 v129, v122, v123
    v_cvt_pk_bf16_f32 v130, v124, v125
    v_cvt_pk_bf16_f32 v131, v126, v127
    s_movk_i32 s11, 18432
    buffer_store_dwordx4 v[128:131], v14, s[24:27], s11 offen sc1
    v_accvgpr_read_b32 v132, a152
    v_accvgpr_read_b32 v133, a153
    v_accvgpr_read_b32 v134, a154
    v_accvgpr_read_b32 v135, a155
    v_accvgpr_read_b32 v136, a156
    v_accvgpr_read_b32 v137, a157
    v_accvgpr_read_b32 v138, a158
    v_accvgpr_read_b32 v139, a159
    v_pk_mul_f32 v[132:133], v[132:133], v[208:209]
    v_pk_mul_f32 v[134:135], v[134:135], v[208:209]
    v_pk_mul_f32 v[136:137], v[136:137], v[208:209]
    v_pk_mul_f32 v[138:139], v[138:139], v[208:209]
    v_cvt_pk_bf16_f32 v140, v132, v133
    v_cvt_pk_bf16_f32 v141, v134, v135
    v_cvt_pk_bf16_f32 v142, v136, v137
    v_cvt_pk_bf16_f32 v143, v138, v139
    s_movk_i32 s11, 19456
    buffer_store_dwordx4 v[140:143], v14, s[24:27], s11 offen sc1
    v_accvgpr_read_b32 v96, a160
    v_accvgpr_read_b32 v97, a161
    v_accvgpr_read_b32 v98, a162
    v_accvgpr_read_b32 v99, a163
    v_accvgpr_read_b32 v100, a164
    v_accvgpr_read_b32 v101, a165
    v_accvgpr_read_b32 v102, a166
    v_accvgpr_read_b32 v103, a167
    v_pk_mul_f32 v[96:97], v[96:97], v[210:211]
    v_pk_mul_f32 v[98:99], v[98:99], v[210:211]
    v_pk_mul_f32 v[100:101], v[100:101], v[210:211]
    v_pk_mul_f32 v[102:103], v[102:103], v[210:211]
    v_cvt_pk_bf16_f32 v104, v96, v97
    v_cvt_pk_bf16_f32 v105, v98, v99
    v_cvt_pk_bf16_f32 v106, v100, v101
    v_cvt_pk_bf16_f32 v107, v102, v103
    s_movk_i32 s11, 20480
    buffer_store_dwordx4 v[104:107], v14, s[24:27], s11 offen sc1
    v_accvgpr_read_b32 v108, a168
    v_accvgpr_read_b32 v109, a169
    v_accvgpr_read_b32 v110, a170
    v_accvgpr_read_b32 v111, a171
    v_accvgpr_read_b32 v112, a172
    v_accvgpr_read_b32 v113, a173
    v_accvgpr_read_b32 v114, a174
    v_accvgpr_read_b32 v115, a175
    v_pk_mul_f32 v[108:109], v[108:109], v[210:211]
    v_pk_mul_f32 v[110:111], v[110:111], v[210:211]
    v_pk_mul_f32 v[112:113], v[112:113], v[210:211]
    v_pk_mul_f32 v[114:115], v[114:115], v[210:211]
    v_cvt_pk_bf16_f32 v116, v108, v109
    v_cvt_pk_bf16_f32 v117, v110, v111
    v_cvt_pk_bf16_f32 v118, v112, v113
    v_cvt_pk_bf16_f32 v119, v114, v115
    s_movk_i32 s11, 21504
    buffer_store_dwordx4 v[116:119], v14, s[24:27], s11 offen sc1
    v_accvgpr_read_b32 v120, a176
    v_accvgpr_read_b32 v121, a177
    v_accvgpr_read_b32 v122, a178
    v_accvgpr_read_b32 v123, a179
    v_accvgpr_read_b32 v124, a180
    v_accvgpr_read_b32 v125, a181
    v_accvgpr_read_b32 v126, a182
    v_accvgpr_read_b32 v127, a183
    v_pk_mul_f32 v[120:121], v[120:121], v[210:211]
    v_pk_mul_f32 v[122:123], v[122:123], v[210:211]
    v_pk_mul_f32 v[124:125], v[124:125], v[210:211]
    v_pk_mul_f32 v[126:127], v[126:127], v[210:211]
    v_cvt_pk_bf16_f32 v128, v120, v121
    v_cvt_pk_bf16_f32 v129, v122, v123
    v_cvt_pk_bf16_f32 v130, v124, v125
    v_cvt_pk_bf16_f32 v131, v126, v127
    s_movk_i32 s11, 22528
    buffer_store_dwordx4 v[128:131], v14, s[24:27], s11 offen sc1
    v_accvgpr_read_b32 v132, a184
    v_accvgpr_read_b32 v133, a185
    v_accvgpr_read_b32 v134, a186
    v_accvgpr_read_b32 v135, a187
    v_accvgpr_read_b32 v136, a188
    v_accvgpr_read_b32 v137, a189
    v_accvgpr_read_b32 v138, a190
    v_accvgpr_read_b32 v139, a191
    v_pk_mul_f32 v[132:133], v[132:133], v[210:211]
    v_pk_mul_f32 v[134:135], v[134:135], v[210:211]
    v_pk_mul_f32 v[136:137], v[136:137], v[210:211]
    v_pk_mul_f32 v[138:139], v[138:139], v[210:211]
    v_cvt_pk_bf16_f32 v140, v132, v133
    v_cvt_pk_bf16_f32 v141, v134, v135
    v_cvt_pk_bf16_f32 v142, v136, v137
    v_cvt_pk_bf16_f32 v143, v138, v139
    s_movk_i32 s11, 23552
    buffer_store_dwordx4 v[140:143], v14, s[24:27], s11 offen sc1
    s_waitcnt lgkmcnt(0)
    v_add_f32 v248, v192, v193
    v_rcp_f32 v222, v248
    s_lshl_b32 s10, s5, 11
    s_add_u32 s10, s10, 49152
    v_add_u32 v14, s10, v11
    v_add_f32 v160, v160, v176
    v_add_f32 v161, v161, v177
    v_add_f32 v162, v162, v178
    v_add_f32 v163, v163, v179
    v_add_f32 v164, v164, v180
    v_add_f32 v165, v165, v181
    v_add_f32 v166, v166, v182
    v_add_f32 v167, v167, v183
    v_add_f32 v168, v168, v184
    v_add_f32 v169, v169, v185
    v_add_f32 v170, v170, v186
    v_add_f32 v171, v171, v187
    v_add_f32 v172, v172, v188
    v_add_f32 v173, v173, v189
    v_add_f32 v174, v174, v190
    v_add_f32 v175, v175, v191
    v_mul_f32 v160, v222, v160
    v_mul_f32 v161, v222, v161
    v_mul_f32 v162, v222, v162
    v_mul_f32 v163, v222, v163
    v_mul_f32 v164, v222, v164
    v_mul_f32 v165, v222, v165
    v_mul_f32 v166, v222, v166
    v_mul_f32 v167, v222, v167
    v_mul_f32 v168, v222, v168
    v_mul_f32 v169, v222, v169
    v_mul_f32 v170, v222, v170
    v_mul_f32 v171, v222, v171
    v_mul_f32 v172, v222, v172
    v_mul_f32 v173, v222, v173
    v_mul_f32 v174, v222, v174
    v_mul_f32 v175, v222, v175
    v_cvt_pk_bf16_f32 v144, v160, v161
    v_cvt_pk_bf16_f32 v145, v162, v163
    v_cvt_pk_bf16_f32 v146, v164, v165
    v_cvt_pk_bf16_f32 v147, v166, v167
    buffer_store_dwordx4 v[144:147], v14, s[24:27], 0 offen offset:0 sc1
    v_cvt_pk_bf16_f32 v148, v168, v169
    v_cvt_pk_bf16_f32 v149, v170, v171
    v_cvt_pk_bf16_f32 v150, v172, v173
    v_cvt_pk_bf16_f32 v151, v174, v175
    buffer_store_dwordx4 v[148:151], v14, s[24:27], 0 offen offset:1024 sc1
L_at_done:
    s_endpgm
L_fallback:
    s_mov_b32 s60, 0
    v_mov_b32 v216, 0xff800000
    v_mov_b32 v217, 0xff800000
    v_mov_b32 v218, 0xff800000
    v_mov_b32 v219, 0xff800000
    v_mov_b32 v220, 0xff800000
    v_mov_b32 v221, 0xff800000
    v_mov_b32 v222, 0xff800000
    v_mov_b32 v12, 0x3f803f80
    v_mov_b32 v13, 0x3f803f80
    v_mov_b32 v14, 0x3f803f80
    v_mov_b32 v15, 0x3f803f80
    v_mov_b32 v2, v4
    v_mov_b32 v3, v5
L_fb_pass:
    s_mov_b32 s37, 0
    s_mov_b32 s38, s51
L_fb_loop:
    s_waitcnt lgkmcnt(0)
    s_barrier
    s_add_u32 m0, s38, 0
    s_nop 0
    buffer_load_dwordx4 v6, s[12:15], s37 offen offset:0 nt lds
    s_add_u32 m0, s38, 800
    s_nop 0
    buffer_load_dwordx4 v6, s[12:15], s37 offen offset:256 nt lds
    s_add_u32 m0, s38, 1600
    s_nop 0
    buffer_load_dwordx4 v6, s[12:15], s37 offen offset:512 nt lds
    s_add_u32 m0, s38, 2400
    s_nop 0
    buffer_load_dwordx4 v6, s[12:15], s37 offen offset:768 nt lds
    s_add_u32 m0, s38, 3200
    s_nop 0
    buffer_load_dwordx4 v6, s[12:15], s37 offen offset:1024 nt lds
    s_add_u32 m0, s38, 4000
    s_nop 0
    buffer_load_dwordx4 v6, s[12:15], s37 offen offset:1280 nt lds
    s_add_u32 m0, s38, 4800
    s_nop 0
    buffer_load_dwordx4 v6, s[12:15], s37 offen offset:1536 nt lds
    s_add_u32 m0, s38, 5600
    s_nop 0
    buffer_load_dwordx4 v6, s[12:15], s37 offen offset:1792 nt lds
    s_waitcnt vmcnt(0)
    s_barrier
    ds_read_b128 v[96:99], v2 offset:0
    ds_read_b128 v[112:115], v2 offset:512
    ds_read_b128 v[100:103], v2 offset:64
    ds_read_b128 v[116:119], v2 offset:576
    ds_read_b128 v[104:107], v2 offset:128
    ds_read_b128 v[120:123], v2 offset:640
    ds_read_b128 v[108:111], v2 offset:192
    ds_read_b128 v[124:127], v2 offset:704
    ds_read_b64_tr_b16 v[128:129], v3 offset:0
    ds_read_b64_tr_b16 v[130:131], v3 offset:512
    ds_read_b64_tr_b16 v[132:133], v3 offset:32
    ds_read_b64_tr_b16 v[134:135], v3 offset:544
    ds_read_b64_tr_b16 v[136:137], v3 offset:64
    ds_read_b64_tr_b16 v[138:139], v3 offset:576
    ds_read_b64_tr_b16 v[140:141], v3 offset:96
    ds_read_b64_tr_b16 v[142:143], v3 offset:608
    ds_read_b64_tr_b16 v[144:145], v3 offset:128
    ds_read_b64_tr_b16 v[146:147], v3 offset:640
    ds_read_b64_tr_b16 v[148:149], v3 offset:160
    ds_read_b64_tr_b16 v[150:151], v3 offset:672
    ds_read_b64_tr_b16 v[152:153], v3 offset:192
    ds_read_b64_tr_b16 v[154:155], v3 offset:704
    ds_read_b64_tr_b16 v[156:157], v3 offset:224
    ds_read_b64_tr_b16 v[158:159], v3 offset:736
    s_waitcnt lgkmcnt(0)
    v_mfma_f32_16x16x32_bf16 v[160:163], v[96:99], v[16:19], 0
    v_mfma_f32_16x16x32_bf16 v[164:167], v[112:115], v[16:19], 0
    v_mfma_f32_16x16x32_bf16 v[160:163], v[100:103], v[20:23], v[160:163]
    v_mfma_f32_16x16x32_bf16 v[164:167], v[116:119], v[20:23], v[164:167]
    v_mfma_f32_16x16x32_bf16 v[160:163], v[104:107], v[24:27], v[160:163]
    v_mfma_f32_16x16x32_bf16 v[164:167], v[120:123], v[24:27], v[164:167]
    v_mfma_f32_16x16x32_bf16 v[160:163], v[108:111], v[28:31], v[160:163]
    v_mfma_f32_16x16x32_bf16 v[164:167], v[124:127], v[28:31], v[164:167]
    s_nop 7
    s_nop 3
    s_cmp_lg_u32 s60, 0
    s_cbranch_scc1 L_fbB_t0
    v_max_f32 v216, v216, v160
    v_max_f32 v216, v216, v161
    v_max_f32 v216, v216, v162
    v_max_f32 v216, v216, v163
    v_max_f32 v216, v216, v164
    v_max_f32 v216, v216, v165
    v_max_f32 v216, v216, v166
    v_max_f32 v216, v216, v167
    s_branch L_fbE_t0
L_fbB_t0:
    v_sub_f32 v160, v160, v216
    v_exp_f32 v160, v160
    v_sub_f32 v161, v161, v216
    v_exp_f32 v161, v161
    v_sub_f32 v162, v162, v216
    v_exp_f32 v162, v162
    v_cvt_pk_bf16_f32 v192, v160, v161
    v_sub_f32 v163, v163, v216
    v_exp_f32 v163, v163
    v_sub_f32 v164, v164, v216
    v_exp_f32 v164, v164
    v_cvt_pk_bf16_f32 v193, v162, v163
    v_sub_f32 v165, v165, v216
    v_exp_f32 v165, v165
    v_sub_f32 v166, v166, v216
    v_exp_f32 v166, v166
    v_cvt_pk_bf16_f32 v194, v164, v165
    v_sub_f32 v167, v167, v216
    v_exp_f32 v167, v167
    s_nop 0
    v_cvt_pk_bf16_f32 v195, v166, v167
    s_nop 1
    v_mfma_f32_16x16x32_bf16 a[0:3], v[128:131], v[192:195], a[0:3]
    v_mfma_f32_16x16x32_bf16 a[4:7], v[132:135], v[192:195], a[4:7]
    v_mfma_f32_16x16x32_bf16 a[8:11], v[136:139], v[192:195], a[8:11]
    v_mfma_f32_16x16x32_bf16 a[12:15], v[140:143], v[192:195], a[12:15]
    v_mfma_f32_16x16x32_bf16 a[16:19], v[144:147], v[192:195], a[16:19]
    v_mfma_f32_16x16x32_bf16 a[20:23], v[148:151], v[192:195], a[20:23]
    v_mfma_f32_16x16x32_bf16 a[24:27], v[152:155], v[192:195], a[24:27]
    v_mfma_f32_16x16x32_bf16 a[28:31], v[156:159], v[192:195], a[28:31]
    v_mfma_f32_16x16x32_bf16 v[224:227], v[12:15], v[192:195], v[224:227]
L_fbE_t0:
    v_mfma_f32_16x16x32_bf16 v[168:171], v[96:99], v[32:35], 0
    v_mfma_f32_16x16x32_bf16 v[172:175], v[112:115], v[32:35], 0
    v_mfma_f32_16x16x32_bf16 v[168:171], v[100:103], v[36:39], v[168:171]
    v_mfma_f32_16x16x32_bf16 v[172:175], v[116:119], v[36:39], v[172:175]
    v_mfma_f32_16x16x32_bf16 v[168:171], v[104:107], v[40:43], v[168:171]
    v_mfma_f32_16x16x32_bf16 v[172:175], v[120:123], v[40:43], v[172:175]
    v_mfma_f32_16x16x32_bf16 v[168:171], v[108:111], v[44:47], v[168:171]
    v_mfma_f32_16x16x32_bf16 v[172:175], v[124:127], v[44:47], v[172:175]
    s_nop 7
    s_nop 3
    s_cmp_lg_u32 s60, 0
    s_cbranch_scc1 L_fbB_t1
    v_max_f32 v217, v217, v168
    v_max_f32 v217, v217, v169
    v_max_f32 v217, v217, v170
    v_max_f32 v217, v217, v171
    v_max_f32 v217, v217, v172
    v_max_f32 v217, v217, v173
    v_max_f32 v217, v217, v174
    v_max_f32 v217, v217, v175
    s_branch L_fbE_t1
L_fbB_t1:
    v_sub_f32 v168, v168, v217
    v_exp_f32 v168, v168
    v_sub_f32 v169, v169, v217
    v_exp_f32 v169, v169
    v_sub_f32 v170, v170, v217
    v_exp_f32 v170, v170
    v_cvt_pk_bf16_f32 v196, v168, v169
    v_sub_f32 v171, v171, v217
    v_exp_f32 v171, v171
    v_sub_f32 v172, v172, v217
    v_exp_f32 v172, v172
    v_cvt_pk_bf16_f32 v197, v170, v171
    v_sub_f32 v173, v173, v217
    v_exp_f32 v173, v173
    v_sub_f32 v174, v174, v217
    v_exp_f32 v174, v174
    v_cvt_pk_bf16_f32 v198, v172, v173
    v_sub_f32 v175, v175, v217
    v_exp_f32 v175, v175
    s_nop 0
    v_cvt_pk_bf16_f32 v199, v174, v175
    s_nop 1
    v_mfma_f32_16x16x32_bf16 a[32:35], v[128:131], v[196:199], a[32:35]
    v_mfma_f32_16x16x32_bf16 a[36:39], v[132:135], v[196:199], a[36:39]
    v_mfma_f32_16x16x32_bf16 a[40:43], v[136:139], v[196:199], a[40:43]
    v_mfma_f32_16x16x32_bf16 a[44:47], v[140:143], v[196:199], a[44:47]
    v_mfma_f32_16x16x32_bf16 a[48:51], v[144:147], v[196:199], a[48:51]
    v_mfma_f32_16x16x32_bf16 a[52:55], v[148:151], v[196:199], a[52:55]
    v_mfma_f32_16x16x32_bf16 a[56:59], v[152:155], v[196:199], a[56:59]
    v_mfma_f32_16x16x32_bf16 a[60:63], v[156:159], v[196:199], a[60:63]
    v_mfma_f32_16x16x32_bf16 v[228:231], v[12:15], v[196:199], v[228:231]
L_fbE_t1:
    v_mfma_f32_16x16x32_bf16 v[176:179], v[96:99], v[48:51], 0
    v_mfma_f32_16x16x32_bf16 v[180:183], v[112:115], v[48:51], 0
    v_mfma_f32_16x16x32_bf16 v[176:179], v[100:103], v[52:55], v[176:179]
    v_mfma_f32_16x16x32_bf16 v[180:183], v[116:119], v[52:55], v[180:183]
    v_mfma_f32_16x16x32_bf16 v[176:179], v[104:107], v[56:59], v[176:179]
    v_mfma_f32_16x16x32_bf16 v[180:183], v[120:123], v[56:59], v[180:183]
    v_mfma_f32_16x16x32_bf16 v[176:179], v[108:111], v[60:63], v[176:179]
    v_mfma_f32_16x16x32_bf16 v[180:183], v[124:127], v[60:63], v[180:183]
    s_nop 7
    s_nop 3
    s_cmp_lg_u32 s60, 0
    s_cbranch_scc1 L_fbB_t2
    v_max_f32 v218, v218, v176
    v_max_f32 v218, v218, v177
    v_max_f32 v218, v218, v178
    v_max_f32 v218, v218, v179
    v_max_f32 v218, v218, v180
    v_max_f32 v218, v218, v181
    v_max_f32 v218, v218, v182
    v_max_f32 v218, v218, v183
    s_branch L_fbE_t2
L_fbB_t2:
    v_sub_f32 v176, v176, v218
    v_exp_f32 v176, v176
    v_sub_f32 v177, v177, v218
    v_exp_f32 v177, v177
    v_sub_f32 v178, v178, v218
    v_exp_f32 v178, v178
    v_cvt_pk_bf16_f32 v200, v176, v177
    v_sub_f32 v179, v179, v218
    v_exp_f32 v179, v179
    v_sub_f32 v180, v180, v218
    v_exp_f32 v180, v180
    v_cvt_pk_bf16_f32 v201, v178, v179
    v_sub_f32 v181, v181, v218
    v_exp_f32 v181, v181
    v_sub_f32 v182, v182, v218
    v_exp_f32 v182, v182
    v_cvt_pk_bf16_f32 v202, v180, v181
    v_sub_f32 v183, v183, v218
    v_exp_f32 v183, v183
    s_nop 0
    v_cvt_pk_bf16_f32 v203, v182, v183
    s_nop 1
    v_mfma_f32_16x16x32_bf16 a[64:67], v[128:131], v[200:203], a[64:67]
    v_mfma_f32_16x16x32_bf16 a[68:71], v[132:135], v[200:203], a[68:71]
    v_mfma_f32_16x16x32_bf16 a[72:75], v[136:139], v[200:203], a[72:75]
    v_mfma_f32_16x16x32_bf16 a[76:79], v[140:143], v[200:203], a[76:79]
    v_mfma_f32_16x16x32_bf16 a[80:83], v[144:147], v[200:203], a[80:83]
    v_mfma_f32_16x16x32_bf16 a[84:87], v[148:151], v[200:203], a[84:87]
    v_mfma_f32_16x16x32_bf16 a[88:91], v[152:155], v[200:203], a[88:91]
    v_mfma_f32_16x16x32_bf16 a[92:95], v[156:159], v[200:203], a[92:95]
    v_mfma_f32_16x16x32_bf16 v[232:235], v[12:15], v[200:203], v[232:235]
L_fbE_t2:
    v_mfma_f32_16x16x32_bf16 v[160:163], v[96:99], v[64:67], 0
    v_mfma_f32_16x16x32_bf16 v[164:167], v[112:115], v[64:67], 0
    v_mfma_f32_16x16x32_bf16 v[160:163], v[100:103], v[68:71], v[160:163]
    v_mfma_f32_16x16x32_bf16 v[164:167], v[116:119], v[68:71], v[164:167]
    v_mfma_f32_16x16x32_bf16 v[160:163], v[104:107], v[72:75], v[160:163]
    v_mfma_f32_16x16x32_bf16 v[164:167], v[120:123], v[72:75], v[164:167]
    v_mfma_f32_16x16x32_bf16 v[160:163], v[108:111], v[76:79], v[160:163]
    v_mfma_f32_16x16x32_bf16 v[164:167], v[124:127], v[76:79], v[164:167]
    s_nop 7
    s_nop 3
    s_cmp_lg_u32 s60, 0
    s_cbranch_scc1 L_fbB_t3
    v_max_f32 v219, v219, v160
    v_max_f32 v219, v219, v161
    v_max_f32 v219, v219, v162
    v_max_f32 v219, v219, v163
    v_max_f32 v219, v219, v164
    v_max_f32 v219, v219, v165
    v_max_f32 v219, v219, v166
    v_max_f32 v219, v219, v167
    s_branch L_fbE_t3
L_fbB_t3:
    v_sub_f32 v160, v160, v219
    v_exp_f32 v160, v160
    v_sub_f32 v161, v161, v219
    v_exp_f32 v161, v161
    v_sub_f32 v162, v162, v219
    v_exp_f32 v162, v162
    v_cvt_pk_bf16_f32 v192, v160, v161
    v_sub_f32 v163, v163, v219
    v_exp_f32 v163, v163
    v_sub_f32 v164, v164, v219
    v_exp_f32 v164, v164
    v_cvt_pk_bf16_f32 v193, v162, v163
    v_sub_f32 v165, v165, v219
    v_exp_f32 v165, v165
    v_sub_f32 v166, v166, v219
    v_exp_f32 v166, v166
    v_cvt_pk_bf16_f32 v194, v164, v165
    v_sub_f32 v167, v167, v219
    v_exp_f32 v167, v167
    s_nop 0
    v_cvt_pk_bf16_f32 v195, v166, v167
    s_nop 1
    v_mfma_f32_16x16x32_bf16 a[96:99], v[128:131], v[192:195], a[96:99]
    v_mfma_f32_16x16x32_bf16 a[100:103], v[132:135], v[192:195], a[100:103]
    v_mfma_f32_16x16x32_bf16 a[104:107], v[136:139], v[192:195], a[104:107]
    v_mfma_f32_16x16x32_bf16 a[108:111], v[140:143], v[192:195], a[108:111]
    v_mfma_f32_16x16x32_bf16 a[112:115], v[144:147], v[192:195], a[112:115]
    v_mfma_f32_16x16x32_bf16 a[116:119], v[148:151], v[192:195], a[116:119]
    v_mfma_f32_16x16x32_bf16 a[120:123], v[152:155], v[192:195], a[120:123]
    v_mfma_f32_16x16x32_bf16 a[124:127], v[156:159], v[192:195], a[124:127]
    v_mfma_f32_16x16x32_bf16 v[236:239], v[12:15], v[192:195], v[236:239]
L_fbE_t3:
    v_mfma_f32_16x16x32_bf16 v[168:171], v[96:99], v[80:83], 0
    v_mfma_f32_16x16x32_bf16 v[172:175], v[112:115], v[80:83], 0
    v_mfma_f32_16x16x32_bf16 v[168:171], v[100:103], v[84:87], v[168:171]
    v_mfma_f32_16x16x32_bf16 v[172:175], v[116:119], v[84:87], v[172:175]
    v_mfma_f32_16x16x32_bf16 v[168:171], v[104:107], v[88:91], v[168:171]
    v_mfma_f32_16x16x32_bf16 v[172:175], v[120:123], v[88:91], v[172:175]
    v_mfma_f32_16x16x32_bf16 v[168:171], v[108:111], v[92:95], v[168:171]
    v_mfma_f32_16x16x32_bf16 v[172:175], v[124:127], v[92:95], v[172:175]
    s_nop 7
    s_nop 3
    s_cmp_lg_u32 s60, 0
    s_cbranch_scc1 L_fbB_t4
    v_max_f32 v220, v220, v168
    v_max_f32 v220, v220, v169
    v_max_f32 v220, v220, v170
    v_max_f32 v220, v220, v171
    v_max_f32 v220, v220, v172
    v_max_f32 v220, v220, v173
    v_max_f32 v220, v220, v174
    v_max_f32 v220, v220, v175
    s_branch L_fbE_t4
L_fbB_t4:
    v_sub_f32 v168, v168, v220
    v_exp_f32 v168, v168
    v_sub_f32 v169, v169, v220
    v_exp_f32 v169, v169
    v_sub_f32 v170, v170, v220
    v_exp_f32 v170, v170
    v_cvt_pk_bf16_f32 v196, v168, v169
    v_sub_f32 v171, v171, v220
    v_exp_f32 v171, v171
    v_sub_f32 v172, v172, v220
    v_exp_f32 v172, v172
    v_cvt_pk_bf16_f32 v197, v170, v171
    v_sub_f32 v173, v173, v220
    v_exp_f32 v173, v173
    v_sub_f32 v174, v174, v220
    v_exp_f32 v174, v174
    v_cvt_pk_bf16_f32 v198, v172, v173
    v_sub_f32 v175, v175, v220
    v_exp_f32 v175, v175
    s_nop 0
    v_cvt_pk_bf16_f32 v199, v174, v175
    s_nop 1
    v_mfma_f32_16x16x32_bf16 a[128:131], v[128:131], v[196:199], a[128:131]
    v_mfma_f32_16x16x32_bf16 a[132:135], v[132:135], v[196:199], a[132:135]
    v_mfma_f32_16x16x32_bf16 a[136:139], v[136:139], v[196:199], a[136:139]
    v_mfma_f32_16x16x32_bf16 a[140:143], v[140:143], v[196:199], a[140:143]
    v_mfma_f32_16x16x32_bf16 a[144:147], v[144:147], v[196:199], a[144:147]
    v_mfma_f32_16x16x32_bf16 a[148:151], v[148:151], v[196:199], a[148:151]
    v_mfma_f32_16x16x32_bf16 a[152:155], v[152:155], v[196:199], a[152:155]
    v_mfma_f32_16x16x32_bf16 a[156:159], v[156:159], v[196:199], a[156:159]
    v_mfma_f32_16x16x32_bf16 v[240:243], v[12:15], v[196:199], v[240:243]
L_fbE_t4:
    v_mfma_f32_16x16x32_bf16 v[176:179], v[96:99], a[224:227], 0
    v_mfma_f32_16x16x32_bf16 v[180:183], v[112:115], a[224:227], 0
    v_mfma_f32_16x16x32_bf16 v[176:179], v[100:103], a[228:231], v[176:179]
    v_mfma_f32_16x16x32_bf16 v[180:183], v[116:119], a[228:231], v[180:183]
    v_mfma_f32_16x16x32_bf16 v[176:179], v[104:107], a[232:235], v[176:179]
    v_mfma_f32_16x16x32_bf16 v[180:183], v[120:123], a[232:235], v[180:183]
    v_mfma_f32_16x16x32_bf16 v[176:179], v[108:111], a[236:239], v[176:179]
    v_mfma_f32_16x16x32_bf16 v[180:183], v[124:127], a[236:239], v[180:183]
    s_nop 7
    s_nop 3
    s_cmp_lg_u32 s60, 0
    s_cbranch_scc1 L_fbB_t5
    v_max_f32 v221, v221, v176
    v_max_f32 v221, v221, v177
    v_max_f32 v221, v221, v178
    v_max_f32 v221, v221, v179
    v_max_f32 v221, v221, v180
    v_max_f32 v221, v221, v181
    v_max_f32 v221, v221, v182
    v_max_f32 v221, v221, v183
    s_branch L_fbE_t5
L_fbB_t5:
    v_sub_f32 v176, v176, v221
    v_exp_f32 v176, v176
    v_sub_f32 v177, v177, v221
    v_exp_f32 v177, v177
    v_sub_f32 v178, v178, v221
    v_exp_f32 v178, v178
    v_cvt_pk_bf16_f32 v200, v176, v177
    v_sub_f32 v179, v179, v221
    v_exp_f32 v179, v179
    v_sub_f32 v180, v180, v221
    v_exp_f32 v180, v180
    v_cvt_pk_bf16_f32 v201, v178, v179
    v_sub_f32 v181, v181, v221
    v_exp_f32 v181, v181
    v_sub_f32 v182, v182, v221
    v_exp_f32 v182, v182
    v_cvt_pk_bf16_f32 v202, v180, v181
    v_sub_f32 v183, v183, v221
    v_exp_f32 v183, v183
    s_nop 0
    v_cvt_pk_bf16_f32 v203, v182, v183
    s_nop 1
    v_mfma_f32_16x16x32_bf16 a[160:163], v[128:131], v[200:203], a[160:163]
    v_mfma_f32_16x16x32_bf16 a[164:167], v[132:135], v[200:203], a[164:167]
    v_mfma_f32_16x16x32_bf16 a[168:171], v[136:139], v[200:203], a[168:171]
    v_mfma_f32_16x16x32_bf16 a[172:175], v[140:143], v[200:203], a[172:175]
    v_mfma_f32_16x16x32_bf16 a[176:179], v[144:147], v[200:203], a[176:179]
    v_mfma_f32_16x16x32_bf16 a[180:183], v[148:151], v[200:203], a[180:183]
    v_mfma_f32_16x16x32_bf16 a[184:187], v[152:155], v[200:203], a[184:187]
    v_mfma_f32_16x16x32_bf16 a[188:191], v[156:159], v[200:203], a[188:191]
    v_mfma_f32_16x16x32_bf16 v[244:247], v[12:15], v[200:203], v[244:247]
L_fbE_t5:
    s_cmp_lg_u32 s5, 0
    s_cbranch_scc1 L_fb_h1
    v_mfma_f32_16x16x32_bf16 v[184:187], v[96:99], a[240:243], 0
    v_mfma_f32_16x16x32_bf16 v[184:187], v[100:103], a[244:247], v[184:187]
    v_mfma_f32_16x16x32_bf16 v[184:187], v[104:107], a[248:251], v[184:187]
    v_mfma_f32_16x16x32_bf16 v[184:187], v[108:111], a[252:255], v[184:187]
    s_nop 7
    s_nop 3
    s_cmp_lg_u32 s60, 0
    s_cbranch_scc1 L_fbB_h0
    v_max_f32 v222, v222, v184
    v_max_f32 v222, v222, v185
    v_max_f32 v222, v222, v186
    v_max_f32 v222, v222, v187
    s_branch L_fbE_h0
L_fbB_h0:
    v_sub_f32 v184, v184, v222
    v_exp_f32 v184, v184
    v_sub_f32 v185, v185, v222
    v_exp_f32 v185, v185
    v_sub_f32 v186, v186, v222
    v_exp_f32 v186, v186
    v_cvt_pk_bf16_f32 v204, v184, v185
    v_sub_f32 v187, v187, v222
    v_exp_f32 v187, v187
    s_nop 0
    v_cvt_pk_bf16_f32 v205, v186, v187
    s_nop 1
    v_mfma_f32_16x16x32_bf16 a[192:195], v[128:131], v[204:207], a[192:195]
    v_mfma_f32_16x16x32_bf16 a[196:199], v[132:135], v[204:207], a[196:199]
    v_mfma_f32_16x16x32_bf16 a[200:203], v[136:139], v[204:207], a[200:203]
    v_mfma_f32_16x16x32_bf16 a[204:207], v[140:143], v[204:207], a[204:207]
    v_mfma_f32_16x16x32_bf16 a[208:211], v[144:147], v[204:207], a[208:211]
    v_mfma_f32_16x16x32_bf16 a[212:215], v[148:151], v[204:207], a[212:215]
    v_mfma_f32_16x16x32_bf16 a[216:219], v[152:155], v[204:207], a[216:219]
    v_mfma_f32_16x16x32_bf16 a[220:223], v[156:159], v[204:207], a[220:223]
    v_mfma_f32_16x16x32_bf16 v[248:251], v[12:15], v[204:207], v[248:251]
L_fbE_h0:
    s_branch L_fb_h2
L_fb_h1:
    v_mfma_f32_16x16x32_bf16 v[184:187], v[112:115], a[240:243], 0
    v_mfma_f32_16x16x32_bf16 v[184:187], v[116:119], a[244:247], v[184:187]
    v_mfma_f32_16x16x32_bf16 v[184:187], v[120:123], a[248:251], v[184:187]
    v_mfma_f32_16x16x32_bf16 v[184:187], v[124:127], a[252:255], v[184:187]
    s_nop 7
    s_nop 3
    s_cmp_lg_u32 s60, 0
    s_cbranch_scc1 L_fbB_h1
    v_max_f32 v222, v222, v184
    v_max_f32 v222, v222, v185
    v_max_f32 v222, v222, v186
    v_max_f32 v222, v222, v187
    s_branch L_fbE_h1
L_fbB_h1:
    v_sub_f32 v184, v184, v222
    v_exp_f32 v184, v184
    v_sub_f32 v185, v185, v222
    v_exp_f32 v185, v185
    v_sub_f32 v186, v186, v222
    v_exp_f32 v186, v186
    v_cvt_pk_bf16_f32 v206, v184, v185
    v_sub_f32 v187, v187, v222
    v_exp_f32 v187, v187
    s_nop 0
    v_cvt_pk_bf16_f32 v207, v186, v187
    s_nop 1
    v_mfma_f32_16x16x32_bf16 a[192:195], v[128:131], v[204:207], a[192:195]
    v_mfma_f32_16x16x32_bf16 a[196:199], v[132:135], v[204:207], a[196:199]
    v_mfma_f32_16x16x32_bf16 a[200:203], v[136:139], v[204:207], a[200:203]
    v_mfma_f32_16x16x32_bf16 a[204:207], v[140:143], v[204:207], a[204:207]
    v_mfma_f32_16x16x32_bf16 a[208:211], v[144:147], v[204:207], a[208:211]
    v_mfma_f32_16x16x32_bf16 a[212:215], v[148:151], v[204:207], a[212:215]
    v_mfma_f32_16x16x32_bf16 a[216:219], v[152:155], v[204:207], a[216:219]
    v_mfma_f32_16x16x32_bf16 a[220:223], v[156:159], v[204:207], a[220:223]
    v_mfma_f32_16x16x32_bf16 v[248:251], v[12:15], v[204:207], v[248:251]
L_fbE_h1:
L_fb_h2:
    s_add_u32 s37, s37, 8192
    s_cmp_lt_u32 s37, 262144
    s_cbranch_scc1 L_fb_loop
    s_nop 7
    s_nop 7
    s_cmp_lg_u32 s60, 0
    s_cbranch_scc1 L_fb_done
    v_mov_b32 v160, v216
    s_nop 1
    v_permlane16_swap_b32 v216, v160
    v_max_f32 v216, v216, v160
    v_mov_b32 v160, v216
    s_nop 1
    v_permlane32_swap_b32 v216, v160
    v_max_f32 v216, v216, v160
    v_mov_b32 v160, v217
    s_nop 1
    v_permlane16_swap_b32 v217, v160
    v_max_f32 v217, v217, v160
    v_mov_b32 v160, v217
    s_nop 1
    v_permlane32_swap_b32 v217, v160
    v_max_f32 v217, v217, v160
    v_mov_b32 v160, v218
    s_nop 1
    v_permlane16_swap_b32 v218, v160
    v_max_f32 v218, v218, v160
    v_mov_b32 v160, v218
    s_nop 1
    v_permlane32_swap_b32 v218, v160
    v_max_f32 v218, v218, v160
    v_mov_b32 v160, v219
    s_nop 1
    v_permlane16_swap_b32 v219, v160
    v_max_f32 v219, v219, v160
    v_mov_b32 v160, v219
    s_nop 1
    v_permlane32_swap_b32 v219, v160
    v_max_f32 v219, v219, v160
    v_mov_b32 v160, v220
    s_nop 1
    v_permlane16_swap_b32 v220, v160
    v_max_f32 v220, v220, v160
    v_mov_b32 v160, v220
    s_nop 1
    v_permlane32_swap_b32 v220, v160
    v_max_f32 v220, v220, v160
    v_mov_b32 v160, v221
    s_nop 1
    v_permlane16_swap_b32 v221, v160
    v_max_f32 v221, v221, v160
    v_mov_b32 v160, v221
    s_nop 1
    v_permlane32_swap_b32 v221, v160
    v_max_f32 v221, v221, v160
    v_mov_b32 v160, v222
    s_nop 1
    v_permlane16_swap_b32 v222, v160
    v_max_f32 v222, v222, v160
    v_mov_b32 v160, v222
    s_nop 1
    v_permlane32_swap_b32 v222, v160
    v_max_f32 v222, v222, v160
    v_lshlrev_b32 v160, 2, v1
    s_lshl_b32 s10, s3, 8
    s_add_u32 s10, s10, 135424
    v_add_u32 v161, s10, v160
    s_xor_b32 s10, s3, 1
    s_lshl_b32 s10, s10, 8
    s_add_u32 s10, s10, 135424
    v_add_u32 v162, s10, v160
    ds_write_b32 v161, v222
    s_waitcnt lgkmcnt(0)
    s_barrier
    ds_read_b32 v163, v162
    s_waitcnt lgkmcnt(0)
    v_max_f32 v222, v222, v163
    v_mov_b32 v160, 0
    v_mov_b32 v161, 0
    v_mov_b32 v162, 0
    v_mov_b32 v163, 0
    v_mov_b32 v224, 0
    v_mov_b32 v225, 0
    v_mov_b32 v226, 0
    v_mov_b32 v227, 0
    v_mov_b32 v228, 0
    v_mov_b32 v229, 0
    v_mov_b32 v230, 0
    v_mov_b32 v231, 0
    v_mov_b32 v232, 0
    v_mov_b32 v233, 0
    v_mov_b32 v234, 0
    v_mov_b32 v235, 0
    v_mov_b32 v236, 0
    v_mov_b32 v237, 0
    v_mov_b32 v238, 0
    v_mov_b32 v239, 0
    v_mov_b32 v240, 0
    v_mov_b32 v241, 0
    v_mov_b32 v242, 0
    v_mov_b32 v243, 0
    v_mov_b32 v244, 0
    v_mov_b32 v245, 0
    v_mov_b32 v246, 0
    v_mov_b32 v247, 0
    v_mov_b32 v248, 0
    v_mov_b32 v249, 0
    v_mov_b32 v250, 0
    v_mov_b32 v251, 0
    v_mov_b32 v204, 0
    v_mov_b32 v205, 0
    v_mov_b32 v206, 0
    v_mov_b32 v207, 0
    v_mfma_f32_32x32x16_bf16 a[0:15], v[160:163], v[160:163], 0
    v_mfma_f32_32x32x16_bf16 a[16:31], v[160:163], v[160:163], 0
    v_mfma_f32_32x32x16_bf16 a[32:47], v[160:163], v[160:163], 0
    v_mfma_f32_32x32x16_bf16 a[48:63], v[160:163], v[160:163], 0
    v_mfma_f32_32x32x16_bf16 a[64:79], v[160:163], v[160:163], 0
    v_mfma_f32_32x32x16_bf16 a[80:95], v[160:163], v[160:163], 0
    v_mfma_f32_32x32x16_bf16 a[96:111], v[160:163], v[160:163], 0
    v_mfma_f32_32x32x16_bf16 a[112:127], v[160:163], v[160:163], 0
    v_mfma_f32_32x32x16_bf16 a[128:143], v[160:163], v[160:163], 0
    v_mfma_f32_32x32x16_bf16 a[144:159], v[160:163], v[160:163], 0
    v_mfma_f32_32x32x16_bf16 a[160:175], v[160:163], v[160:163], 0
    v_mfma_f32_32x32x16_bf16 a[176:191], v[160:163], v[160:163], 0
    v_mfma_f32_32x32x16_bf16 a[192:207], v[160:163], v[160:163], 0
    v_mfma_f32_32x32x16_bf16 a[208:223], v[160:163], v[160:163], 0
    s_nop 7
    s_nop 7
    s_mov_b32 s60, 1
    s_branch L_fb_pass
L_fb_done:
    s_waitcnt vmcnt(0) lgkmcnt(0)
    s_barrier
    s_branch L_epi
.globl oproj_kernel
.p2align 8
.type oproj_kernel,@function
oproj_kernel:
    s_cmp_ge_u32 s2, 256
    s_cbranch_scc1 L_op_done
    s_load_dwordx2 s[8:9], s[0:1], 80
    s_load_dwordx2 s[10:11], s[0:1], 96
    v_and_b32 v1, 63, v0
    v_lshrrev_b32 v2, 6, v0
    s_and_b32 s12, s2, 7
    v_readfirstlane_b32 s13, v2
    s_lshr_b32 s14, s12, 2
    s_and_b32 s15, s12, 3
    s_lshl_b32 s15, s15, 1
    s_lshr_b32 s16, s2, 3
    s_and_b32 s16, s16, 1
    s_add_u32 s15, s15, s16
    s_lshr_b32 s17, s2, 4
    s_and_b32 s18, s17, 1
    s_lshr_b32 s19, s17, 1
    v_lshrrev_b32 v3, 4, v1
    v_and_b32 v4, 15, v1
    v_lshlrev_b32 v2, 4, v1
    v_add_u32 v9, 4096, v2
    v_add_u32 v10, 8192, v2
    v_add_u32 v11, 12288, v2
    v_add_u32 v12, 16384, v2
    v_add_u32 v13, 20480, v2
    v_add_u32 v14, 24576, v2
    v_mov_b32 v8, v2
    v_add_u32 v15, 4096, v2
    s_waitcnt lgkmcnt(0)
    s_lshl_b32 s36, s14, 3
    s_add_u32 s36, s36, s15
    s_lshl_b32 s36, s36, 5
    s_lshl_b32 s37, s13, 3
    s_add_u32 s36, s36, s37
    s_mul_i32 s36, s36, 53248
    s_mul_i32 s37, s18, 24576
    s_add_u32 s36, s36, s37
    s_add_u32 s24, s10, s36
    s_addc_u32 s25, s11, 0
    s_and_b32 s25, s25, 0xffff
    s_sub_u32 s26, 425984, s37
    s_mov_b32 s27, 0x20000
    s_lshl_b32 s36, s14, 7
    s_lshl_b32 s37, s13, 5
    s_add_u32 s36, s36, s37
    s_mul_i32 s36, s36, 40960
    s_mul_i32 s37, s19, 5120
    s_add_u32 s36, s36, s37
    s_add_u32 s36, s36, 27262976
    s_add_u32 s28, s10, s36
    s_addc_u32 s29, s11, 0
    s_and_b32 s29, s29, 0xffff
    s_sub_u32 s30, 1310720, s37
    s_mov_b32 s31, 0x20000
    s_mov_b32 s32, s8
    s_and_b32 s33, s9, 0xffff
    s_mov_b32 s34, 4259840
    s_mov_b32 s35, 0x20000
    s_mov_b32 s40, 0
    s_mov_b32 s41, 0
    buffer_load_dwordx4 v[60:63], v8, s[28:31], s41 offen offset:0
    buffer_load_dwordx4 v[64:67], v8, s[28:31], s41 offen offset:1024
    buffer_load_dwordx4 v[68:71], v8, s[28:31], s41 offen offset:2048
    buffer_load_dwordx4 v[72:75], v8, s[28:31], s41 offen offset:3072
    buffer_load_dwordx4 v[76:79], v15, s[28:31], s41 offen
    buffer_load_dwordx4 v[32:35], v8, s[24:27], s40 offen
    buffer_load_dwordx4 v[36:39], v9, s[24:27], s40 offen
    buffer_load_dwordx4 v[40:43], v10, s[24:27], s40 offen
    buffer_load_dwordx4 v[44:47], v11, s[24:27], s40 offen
    buffer_load_dwordx4 v[48:51], v12, s[24:27], s40 offen
    buffer_load_dwordx4 v[52:55], v13, s[24:27], s40 offen
    buffer_load_dwordx4 v[56:59], v14, s[24:27], s40 offen
    s_add_u32 s40, s40, 1024
    s_add_u32 s41, s41, 40960
    buffer_load_dwordx4 v[108:111], v8, s[28:31], s41 offen offset:0
    buffer_load_dwordx4 v[112:115], v8, s[28:31], s41 offen offset:1024
    buffer_load_dwordx4 v[116:119], v8, s[28:31], s41 offen offset:2048
    buffer_load_dwordx4 v[120:123], v8, s[28:31], s41 offen offset:3072
    buffer_load_dwordx4 v[124:127], v15, s[28:31], s41 offen
    buffer_load_dwordx4 v[80:83], v8, s[24:27], s40 offen
    buffer_load_dwordx4 v[84:87], v9, s[24:27], s40 offen
    buffer_load_dwordx4 v[88:91], v10, s[24:27], s40 offen
    buffer_load_dwordx4 v[92:95], v11, s[24:27], s40 offen
    buffer_load_dwordx4 v[96:99], v12, s[24:27], s40 offen
    buffer_load_dwordx4 v[100:103], v13, s[24:27], s40 offen
    buffer_load_dwordx4 v[104:107], v14, s[24:27], s40 offen
    s_add_u32 s40, s40, 1024
    s_add_u32 s41, s41, 40960
    buffer_load_dwordx4 v[156:159], v8, s[28:31], s41 offen offset:0
    buffer_load_dwordx4 v[160:163], v8, s[28:31], s41 offen offset:1024
    buffer_load_dwordx4 v[164:167], v8, s[28:31], s41 offen offset:2048
    buffer_load_dwordx4 v[168:171], v8, s[28:31], s41 offen offset:3072
    buffer_load_dwordx4 v[172:175], v15, s[28:31], s41 offen
    buffer_load_dwordx4 v[128:131], v8, s[24:27], s40 offen
    buffer_load_dwordx4 v[132:135], v9, s[24:27], s40 offen
    buffer_load_dwordx4 v[136:139], v10, s[24:27], s40 offen
    buffer_load_dwordx4 v[140:143], v11, s[24:27], s40 offen
    buffer_load_dwordx4 v[144:147], v12, s[24:27], s40 offen
    buffer_load_dwordx4 v[148:151], v13, s[24:27], s40 offen
    buffer_load_dwordx4 v[152:155], v14, s[24:27], s40 offen
    s_add_u32 s40, s40, 1024
    s_add_u32 s41, s41, 40960
    v_mov_b32 v24, 0
    v_mov_b32 v25, 0
    v_mov_b32 v26, 0
    v_mov_b32 v27, 0
    s_nop 1
    v_mfma_f32_32x32x16_bf16 a[0:15], v[24:27], v[24:27], 0
    v_mfma_f32_32x32x16_bf16 a[16:31], v[24:27], v[24:27], 0
    v_mfma_f32_32x32x16_bf16 a[32:47], v[24:27], v[24:27], 0
    v_mfma_f32_32x32x16_bf16 a[48:63], v[24:27], v[24:27], 0
    v_mfma_f32_32x32x16_bf16 a[64:79], v[24:27], v[24:27], 0
    v_mfma_f32_32x32x16_bf16 a[80:95], v[24:27], v[24:27], 0
    v_mfma_f32_32x32x16_bf16 a[96:111], v[24:27], v[24:27], 0
    v_mfma_f32_32x32x16_bf16 a[112:127], v[24:27], v[24:27], 0
    v_mfma_f32_32x32x16_bf16 a[128:143], v[24:27], v[24:27], 0
    s_nop 7
    s_nop 3
    s_mov_b32 s43, 0
L_op_loop:
    s_waitcnt vmcnt(24)
    v_mfma_f32_16x16x32_bf16 a[0:3], v[60:63], v[32:35], a[0:3]
    v_mfma_f32_16x16x32_bf16 a[4:7], v[64:67], v[32:35], a[4:7]
    buffer_load_dwordx4 v[204:207], v8, s[28:31], s41 offen offset:0
    v_mfma_f32_16x16x32_bf16 a[8:11], v[68:71], v[32:35], a[8:11]
    v_mfma_f32_16x16x32_bf16 a[12:15], v[72:75], v[32:35], a[12:15]
    v_mfma_f32_16x16x32_bf16 a[16:19], v[76:79], v[32:35], a[16:19]
    buffer_load_dwordx4 v[208:211], v8, s[28:31], s41 offen offset:1024
    v_mfma_f32_16x16x32_bf16 a[20:23], v[60:63], v[36:39], a[20:23]
    v_mfma_f32_16x16x32_bf16 a[24:27], v[64:67], v[36:39], a[24:27]
    v_mfma_f32_16x16x32_bf16 a[28:31], v[68:71], v[36:39], a[28:31]
    buffer_load_dwordx4 v[212:215], v8, s[28:31], s41 offen offset:2048
    v_mfma_f32_16x16x32_bf16 a[32:35], v[72:75], v[36:39], a[32:35]
    v_mfma_f32_16x16x32_bf16 a[36:39], v[76:79], v[36:39], a[36:39]
    v_mfma_f32_16x16x32_bf16 a[40:43], v[60:63], v[40:43], a[40:43]
    buffer_load_dwordx4 v[216:219], v8, s[28:31], s41 offen offset:3072
    v_mfma_f32_16x16x32_bf16 a[44:47], v[64:67], v[40:43], a[44:47]
    v_mfma_f32_16x16x32_bf16 a[48:51], v[68:71], v[40:43], a[48:51]
    v_mfma_f32_16x16x32_bf16 a[52:55], v[72:75], v[40:43], a[52:55]
    buffer_load_dwordx4 v[220:223], v15, s[28:31], s41 offen
    v_mfma_f32_16x16x32_bf16 a[56:59], v[76:79], v[40:43], a[56:59]
    v_mfma_f32_16x16x32_bf16 a[60:63], v[60:63], v[44:47], a[60:63]
    v_mfma_f32_16x16x32_bf16 a[64:67], v[64:67], v[44:47], a[64:67]
    buffer_load_dwordx4 v[176:179], v8, s[24:27], s40 offen
    v_mfma_f32_16x16x32_bf16 a[68:71], v[68:71], v[44:47], a[68:71]
    v_mfma_f32_16x16x32_bf16 a[72:75], v[72:75], v[44:47], a[72:75]
    v_mfma_f32_16x16x32_bf16 a[76:79], v[76:79], v[44:47], a[76:79]
    buffer_load_dwordx4 v[180:183], v9, s[24:27], s40 offen
    v_mfma_f32_16x16x32_bf16 a[80:83], v[60:63], v[48:51], a[80:83]
    v_mfma_f32_16x16x32_bf16 a[84:87], v[64:67], v[48:51], a[84:87]
    v_mfma_f32_16x16x32_bf16 a[88:91], v[68:71], v[48:51], a[88:91]
    buffer_load_dwordx4 v[184:187], v10, s[24:27], s40 offen
    v_mfma_f32_16x16x32_bf16 a[92:95], v[72:75], v[48:51], a[92:95]
    v_mfma_f32_16x16x32_bf16 a[96:99], v[76:79], v[48:51], a[96:99]
    v_mfma_f32_16x16x32_bf16 a[100:103], v[60:63], v[52:55], a[100:103]
    buffer_load_dwordx4 v[188:191], v11, s[24:27], s40 offen
    v_mfma_f32_16x16x32_bf16 a[104:107], v[64:67], v[52:55], a[104:107]
    v_mfma_f32_16x16x32_bf16 a[108:111], v[68:71], v[52:55], a[108:111]
    v_mfma_f32_16x16x32_bf16 a[112:115], v[72:75], v[52:55], a[112:115]
    buffer_load_dwordx4 v[192:195], v12, s[24:27], s40 offen
    v_mfma_f32_16x16x32_bf16 a[116:119], v[76:79], v[52:55], a[116:119]
    v_mfma_f32_16x16x32_bf16 a[120:123], v[60:63], v[56:59], a[120:123]
    v_mfma_f32_16x16x32_bf16 a[124:127], v[64:67], v[56:59], a[124:127]
    buffer_load_dwordx4 v[196:199], v13, s[24:27], s40 offen
    v_mfma_f32_16x16x32_bf16 a[128:131], v[68:71], v[56:59], a[128:131]
    v_mfma_f32_16x16x32_bf16 a[132:135], v[72:75], v[56:59], a[132:135]
    v_mfma_f32_16x16x32_bf16 a[136:139], v[76:79], v[56:59], a[136:139]
    buffer_load_dwordx4 v[200:203], v14, s[24:27], s40 offen
    s_add_u32 s40, s40, 50176
    s_add_u32 s41, s41, 40960
    s_waitcnt vmcnt(24)
    v_mfma_f32_16x16x32_bf16 a[0:3], v[108:111], v[80:83], a[0:3]
    v_mfma_f32_16x16x32_bf16 a[4:7], v[112:115], v[80:83], a[4:7]
    buffer_load_dwordx4 v[60:63], v8, s[28:31], s41 offen offset:0
    v_mfma_f32_16x16x32_bf16 a[8:11], v[116:119], v[80:83], a[8:11]
    v_mfma_f32_16x16x32_bf16 a[12:15], v[120:123], v[80:83], a[12:15]
    v_mfma_f32_16x16x32_bf16 a[16:19], v[124:127], v[80:83], a[16:19]
    buffer_load_dwordx4 v[64:67], v8, s[28:31], s41 offen offset:1024
    v_mfma_f32_16x16x32_bf16 a[20:23], v[108:111], v[84:87], a[20:23]
    v_mfma_f32_16x16x32_bf16 a[24:27], v[112:115], v[84:87], a[24:27]
    v_mfma_f32_16x16x32_bf16 a[28:31], v[116:119], v[84:87], a[28:31]
    buffer_load_dwordx4 v[68:71], v8, s[28:31], s41 offen offset:2048
    v_mfma_f32_16x16x32_bf16 a[32:35], v[120:123], v[84:87], a[32:35]
    v_mfma_f32_16x16x32_bf16 a[36:39], v[124:127], v[84:87], a[36:39]
    v_mfma_f32_16x16x32_bf16 a[40:43], v[108:111], v[88:91], a[40:43]
    buffer_load_dwordx4 v[72:75], v8, s[28:31], s41 offen offset:3072
    v_mfma_f32_16x16x32_bf16 a[44:47], v[112:115], v[88:91], a[44:47]
    v_mfma_f32_16x16x32_bf16 a[48:51], v[116:119], v[88:91], a[48:51]
    v_mfma_f32_16x16x32_bf16 a[52:55], v[120:123], v[88:91], a[52:55]
    buffer_load_dwordx4 v[76:79], v15, s[28:31], s41 offen
    v_mfma_f32_16x16x32_bf16 a[56:59], v[124:127], v[88:91], a[56:59]
    v_mfma_f32_16x16x32_bf16 a[60:63], v[108:111], v[92:95], a[60:63]
    v_mfma_f32_16x16x32_bf16 a[64:67], v[112:115], v[92:95], a[64:67]
    buffer_load_dwordx4 v[32:35], v8, s[24:27], s40 offen
    v_mfma_f32_16x16x32_bf16 a[68:71], v[116:119], v[92:95], a[68:71]
    v_mfma_f32_16x16x32_bf16 a[72:75], v[120:123], v[92:95], a[72:75]
    v_mfma_f32_16x16x32_bf16 a[76:79], v[124:127], v[92:95], a[76:79]
    buffer_load_dwordx4 v[36:39], v9, s[24:27], s40 offen
    v_mfma_f32_16x16x32_bf16 a[80:83], v[108:111], v[96:99], a[80:83]
    v_mfma_f32_16x16x32_bf16 a[84:87], v[112:115], v[96:99], a[84:87]
    v_mfma_f32_16x16x32_bf16 a[88:91], v[116:119], v[96:99], a[88:91]
    buffer_load_dwordx4 v[40:43], v10, s[24:27], s40 offen
    v_mfma_f32_16x16x32_bf16 a[92:95], v[120:123], v[96:99], a[92:95]
    v_mfma_f32_16x16x32_bf16 a[96:99], v[124:127], v[96:99], a[96:99]
    v_mfma_f32_16x16x32_bf16 a[100:103], v[108:111], v[100:103], a[100:103]
    buffer_load_dwordx4 v[44:47], v11, s[24:27], s40 offen
    v_mfma_f32_16x16x32_bf16 a[104:107], v[112:115], v[100:103], a[104:107]
    v_mfma_f32_16x16x32_bf16 a[108:111], v[116:119], v[100:103], a[108:111]
    v_mfma_f32_16x16x32_bf16 a[112:115], v[120:123], v[100:103], a[112:115]
    buffer_load_dwordx4 v[48:51], v12, s[24:27], s40 offen
    v_mfma_f32_16x16x32_bf16 a[116:119], v[124:127], v[100:103], a[116:119]
    v_mfma_f32_16x16x32_bf16 a[120:123], v[108:111], v[104:107], a[120:123]
    v_mfma_f32_16x16x32_bf16 a[124:127], v[112:115], v[104:107], a[124:127]
    buffer_load_dwordx4 v[52:55], v13, s[24:27], s40 offen
    v_mfma_f32_16x16x32_bf16 a[128:131], v[116:119], v[104:107], a[128:131]
    v_mfma_f32_16x16x32_bf16 a[132:135], v[120:123], v[104:107], a[132:135]
    v_mfma_f32_16x16x32_bf16 a[136:139], v[124:127], v[104:107], a[136:139]
    buffer_load_dwordx4 v[56:59], v14, s[24:27], s40 offen
    s_add_u32 s40, s40, 1024
    s_add_u32 s41, s41, 40960
    s_waitcnt vmcnt(24)
    v_mfma_f32_16x16x32_bf16 a[0:3], v[156:159], v[128:131], a[0:3]
    v_mfma_f32_16x16x32_bf16 a[4:7], v[160:163], v[128:131], a[4:7]
    buffer_load_dwordx4 v[108:111], v8, s[28:31], s41 offen offset:0
    v_mfma_f32_16x16x32_bf16 a[8:11], v[164:167], v[128:131], a[8:11]
    v_mfma_f32_16x16x32_bf16 a[12:15], v[168:171], v[128:131], a[12:15]
    v_mfma_f32_16x16x32_bf16 a[16:19], v[172:175], v[128:131], a[16:19]
    buffer_load_dwordx4 v[112:115], v8, s[28:31], s41 offen offset:1024
    v_mfma_f32_16x16x32_bf16 a[20:23], v[156:159], v[132:135], a[20:23]
    v_mfma_f32_16x16x32_bf16 a[24:27], v[160:163], v[132:135], a[24:27]
    v_mfma_f32_16x16x32_bf16 a[28:31], v[164:167], v[132:135], a[28:31]
    buffer_load_dwordx4 v[116:119], v8, s[28:31], s41 offen offset:2048
    v_mfma_f32_16x16x32_bf16 a[32:35], v[168:171], v[132:135], a[32:35]
    v_mfma_f32_16x16x32_bf16 a[36:39], v[172:175], v[132:135], a[36:39]
    v_mfma_f32_16x16x32_bf16 a[40:43], v[156:159], v[136:139], a[40:43]
    buffer_load_dwordx4 v[120:123], v8, s[28:31], s41 offen offset:3072
    v_mfma_f32_16x16x32_bf16 a[44:47], v[160:163], v[136:139], a[44:47]
    v_mfma_f32_16x16x32_bf16 a[48:51], v[164:167], v[136:139], a[48:51]
    v_mfma_f32_16x16x32_bf16 a[52:55], v[168:171], v[136:139], a[52:55]
    buffer_load_dwordx4 v[124:127], v15, s[28:31], s41 offen
    v_mfma_f32_16x16x32_bf16 a[56:59], v[172:175], v[136:139], a[56:59]
    v_mfma_f32_16x16x32_bf16 a[60:63], v[156:159], v[140:143], a[60:63]
    v_mfma_f32_16x16x32_bf16 a[64:67], v[160:163], v[140:143], a[64:67]
    buffer_load_dwordx4 v[80:83], v8, s[24:27], s40 offen
    v_mfma_f32_16x16x32_bf16 a[68:71], v[164:167], v[140:143], a[68:71]
    v_mfma_f32_16x16x32_bf16 a[72:75], v[168:171], v[140:143], a[72:75]
    v_mfma_f32_16x16x32_bf16 a[76:79], v[172:175], v[140:143], a[76:79]
    buffer_load_dwordx4 v[84:87], v9, s[24:27], s40 offen
    v_mfma_f32_16x16x32_bf16 a[80:83], v[156:159], v[144:147], a[80:83]
    v_mfma_f32_16x16x32_bf16 a[84:87], v[160:163], v[144:147], a[84:87]
    v_mfma_f32_16x16x32_bf16 a[88:91], v[164:167], v[144:147], a[88:91]
    buffer_load_dwordx4 v[88:91], v10, s[24:27], s40 offen
    v_mfma_f32_16x16x32_bf16 a[92:95], v[168:171], v[144:147], a[92:95]
    v_mfma_f32_16x16x32_bf16 a[96:99], v[172:175], v[144:147], a[96:99]
    v_mfma_f32_16x16x32_bf16 a[100:103], v[156:159], v[148:151], a[100:103]
    buffer_load_dwordx4 v[92:95], v11, s[24:27], s40 offen
    v_mfma_f32_16x16x32_bf16 a[104:107], v[160:163], v[148:151], a[104:107]
    v_mfma_f32_16x16x32_bf16 a[108:111], v[164:167], v[148:151], a[108:111]
    v_mfma_f32_16x16x32_bf16 a[112:115], v[168:171], v[148:151], a[112:115]
    buffer_load_dwordx4 v[96:99], v12, s[24:27], s40 offen
    v_mfma_f32_16x16x32_bf16 a[116:119], v[172:175], v[148:151], a[116:119]
    v_mfma_f32_16x16x32_bf16 a[120:123], v[156:159], v[152:155], a[120:123]
    v_mfma_f32_16x16x32_bf16 a[124:127], v[160:163], v[152:155], a[124:127]
    buffer_load_dwordx4 v[100:103], v13, s[24:27], s40 offen
    v_mfma_f32_16x16x32_bf16 a[128:131], v[164:167], v[152:155], a[128:131]
    v_mfma_f32_16x16x32_bf16 a[132:135], v[168:171], v[152:155], a[132:135]
    v_mfma_f32_16x16x32_bf16 a[136:139], v[172:175], v[152:155], a[136:139]
    buffer_load_dwordx4 v[104:107], v14, s[24:27], s40 offen
    s_add_u32 s40, s40, 1024
    s_add_u32 s41, s41, 40960
    s_waitcnt vmcnt(24)
    v_mfma_f32_16x16x32_bf16 a[0:3], v[204:207], v[176:179], a[0:3]
    v_mfma_f32_16x16x32_bf16 a[4:7], v[208:211], v[176:179], a[4:7]
    buffer_load_dwordx4 v[156:159], v8, s[28:31], s41 offen offset:0
    v_mfma_f32_16x16x32_bf16 a[8:11], v[212:215], v[176:179], a[8:11]
    v_mfma_f32_16x16x32_bf16 a[12:15], v[216:219], v[176:179], a[12:15]
    v_mfma_f32_16x16x32_bf16 a[16:19], v[220:223], v[176:179], a[16:19]
    buffer_load_dwordx4 v[160:163], v8, s[28:31], s41 offen offset:1024
    v_mfma_f32_16x16x32_bf16 a[20:23], v[204:207], v[180:183], a[20:23]
    v_mfma_f32_16x16x32_bf16 a[24:27], v[208:211], v[180:183], a[24:27]
    v_mfma_f32_16x16x32_bf16 a[28:31], v[212:215], v[180:183], a[28:31]
    buffer_load_dwordx4 v[164:167], v8, s[28:31], s41 offen offset:2048
    v_mfma_f32_16x16x32_bf16 a[32:35], v[216:219], v[180:183], a[32:35]
    v_mfma_f32_16x16x32_bf16 a[36:39], v[220:223], v[180:183], a[36:39]
    v_mfma_f32_16x16x32_bf16 a[40:43], v[204:207], v[184:187], a[40:43]
    buffer_load_dwordx4 v[168:171], v8, s[28:31], s41 offen offset:3072
    v_mfma_f32_16x16x32_bf16 a[44:47], v[208:211], v[184:187], a[44:47]
    v_mfma_f32_16x16x32_bf16 a[48:51], v[212:215], v[184:187], a[48:51]
    v_mfma_f32_16x16x32_bf16 a[52:55], v[216:219], v[184:187], a[52:55]
    buffer_load_dwordx4 v[172:175], v15, s[28:31], s41 offen
    v_mfma_f32_16x16x32_bf16 a[56:59], v[220:223], v[184:187], a[56:59]
    v_mfma_f32_16x16x32_bf16 a[60:63], v[204:207], v[188:191], a[60:63]
    v_mfma_f32_16x16x32_bf16 a[64:67], v[208:211], v[188:191], a[64:67]
    buffer_load_dwordx4 v[128:131], v8, s[24:27], s40 offen
    v_mfma_f32_16x16x32_bf16 a[68:71], v[212:215], v[188:191], a[68:71]
    v_mfma_f32_16x16x32_bf16 a[72:75], v[216:219], v[188:191], a[72:75]
    v_mfma_f32_16x16x32_bf16 a[76:79], v[220:223], v[188:191], a[76:79]
    buffer_load_dwordx4 v[132:135], v9, s[24:27], s40 offen
    v_mfma_f32_16x16x32_bf16 a[80:83], v[204:207], v[192:195], a[80:83]
    v_mfma_f32_16x16x32_bf16 a[84:87], v[208:211], v[192:195], a[84:87]
    v_mfma_f32_16x16x32_bf16 a[88:91], v[212:215], v[192:195], a[88:91]
    buffer_load_dwordx4 v[136:139], v10, s[24:27], s40 offen
    v_mfma_f32_16x16x32_bf16 a[92:95], v[216:219], v[192:195], a[92:95]
    v_mfma_f32_16x16x32_bf16 a[96:99], v[220:223], v[192:195], a[96:99]
    v_mfma_f32_16x16x32_bf16 a[100:103], v[204:207], v[196:199], a[100:103]
    buffer_load_dwordx4 v[140:143], v11, s[24:27], s40 offen
    v_mfma_f32_16x16x32_bf16 a[104:107], v[208:211], v[196:199], a[104:107]
    v_mfma_f32_16x16x32_bf16 a[108:111], v[212:215], v[196:199], a[108:111]
    v_mfma_f32_16x16x32_bf16 a[112:115], v[216:219], v[196:199], a[112:115]
    buffer_load_dwordx4 v[144:147], v12, s[24:27], s40 offen
    v_mfma_f32_16x16x32_bf16 a[116:119], v[220:223], v[196:199], a[116:119]
    v_mfma_f32_16x16x32_bf16 a[120:123], v[204:207], v[200:203], a[120:123]
    v_mfma_f32_16x16x32_bf16 a[124:127], v[208:211], v[200:203], a[124:127]
    buffer_load_dwordx4 v[148:151], v13, s[24:27], s40 offen
    v_mfma_f32_16x16x32_bf16 a[128:131], v[212:215], v[200:203], a[128:131]
    v_mfma_f32_16x16x32_bf16 a[132:135], v[216:219], v[200:203], a[132:135]
    v_mfma_f32_16x16x32_bf16 a[136:139], v[220:223], v[200:203], a[136:139]
    buffer_load_dwordx4 v[152:155], v14, s[24:27], s40 offen
    s_add_u32 s40, s40, 1024
    s_add_u32 s41, s41, 40960
    s_add_u32 s43, s43, 1
    s_cmp_lt_u32 s43, 8
    s_cbranch_scc1 L_op_loop
    s_mul_i32 s44, s13, 35840
    v_add_u32 v5, s44, v2
    ds_write_b128 v5, a[0:3] offset:0
    ds_write_b128 v5, a[4:7] offset:1024
    ds_write_b128 v5, a[8:11] offset:2048
    ds_write_b128 v5, a[12:15] offset:3072
    ds_write_b128 v5, a[16:19] offset:4096
    ds_write_b128 v5, a[20:23] offset:5120
    ds_write_b128 v5, a[24:27] offset:6144
    ds_write_b128 v5, a[28:31] offset:7168
    ds_write_b128 v5, a[32:35] offset:8192
    ds_write_b128 v5, a[36:39] offset:9216
    ds_write_b128 v5, a[40:43] offset:10240
    ds_write_b128 v5, a[44:47] offset:11264
    ds_write_b128 v5, a[48:51] offset:12288
    ds_write_b128 v5, a[52:55] offset:13312
    ds_write_b128 v5, a[56:59] offset:14336
    ds_write_b128 v5, a[60:63] offset:15360
    ds_write_b128 v5, a[64:67] offset:16384
    ds_write_b128 v5, a[68:71] offset:17408
    ds_write_b128 v5, a[72:75] offset:18432
    ds_write_b128 v5, a[76:79] offset:19456
    ds_write_b128 v5, a[80:83] offset:20480
    ds_write_b128 v5, a[84:87] offset:21504
    ds_write_b128 v5, a[88:91] offset:22528
    ds_write_b128 v5, a[92:95] offset:23552
    ds_write_b128 v5, a[96:99] offset:24576
    ds_write_b128 v5, a[100:103] offset:25600
    ds_write_b128 v5, a[104:107] offset:26624
    ds_write_b128 v5, a[108:111] offset:27648
    ds_write_b128 v5, a[112:115] offset:28672
    ds_write_b128 v5, a[116:119] offset:29696
    ds_write_b128 v5, a[120:123] offset:30720
    ds_write_b128 v5, a[124:127] offset:31744
    ds_write_b128 v5, a[128:131] offset:32768
    ds_write_b128 v5, a[132:135] offset:33792
    ds_write_b128 v5, a[136:139] offset:34816
    s_waitcnt vmcnt(0) lgkmcnt(0)
    s_barrier
    s_add_u32 s45, s13, 4
    s_cmp_lt_u32 s13, 3
    s_cselect_b32 s45, s45, s13
    s_mul_i32 s46, s15, 208
    s_mul_i32 s47, s18, 96
    s_add_u32 s46, s46, s47
    s_mul_i32 s47, s14, 1280
    s_mul_i32 s48, s19, 160
    s_add_u32 s47, s47, s48
    s_movk_i32 s49, 2560
    s_mul_i32 s50, s13, 5120
    v_add_u32 v6, s50, v2
    v_add_u32 v7, 71680, v6
    ds_read_b128 v[64:67], v6 offset:0
    ds_read_b128 v[68:71], v6 offset:1024
    ds_read_b128 v[72:75], v6 offset:2048
    ds_read_b128 v[76:79], v6 offset:3072
    ds_read_b128 v[80:83], v6 offset:4096
    ds_read_b128 v[84:87], v6 offset:35840
    ds_read_b128 v[88:91], v6 offset:36864
    ds_read_b128 v[92:95], v6 offset:37888
    ds_read_b128 v[96:99], v6 offset:38912
    ds_read_b128 v[100:103], v6 offset:39936
    ds_read_b128 v[104:107], v7 offset:0
    ds_read_b128 v[108:111], v7 offset:1024
    ds_read_b128 v[112:115], v7 offset:2048
    ds_read_b128 v[116:119], v7 offset:3072
    ds_read_b128 v[120:123], v7 offset:4096
    ds_read_b128 v[124:127], v7 offset:35840
    ds_read_b128 v[128:131], v7 offset:36864
    ds_read_b128 v[132:135], v7 offset:37888
    ds_read_b128 v[136:139], v7 offset:38912
    ds_read_b128 v[140:143], v7 offset:39936
    s_lshl_b32 s51, s13, 4
    s_add_u32 s51, s51, s46
    v_add_u32 v19, s51, v4
    v_mul_lo_u32 v19, v19, s49
    v_add_u32 v19, s47, v19
    v_lshl_add_u32 v20, v3, 4, v19
    v_lshl_add_u32 v21, v3, 3, v19
    s_waitcnt lgkmcnt(2)
    v_add_f32 v64, v64, v84
    v_add_f32 v104, v104, v124
    v_add_f32 v65, v65, v85
    v_add_f32 v105, v105, v125
    v_add_f32 v66, v66, v86
    v_add_f32 v106, v106, v126
    v_add_f32 v67, v67, v87
    v_add_f32 v107, v107, v127
    v_add_f32 v64, v64, v104
    v_add_f32 v65, v65, v105
    v_add_f32 v66, v66, v106
    v_add_f32 v67, v67, v107
    v_add_f32 v68, v68, v88
    v_add_f32 v108, v108, v128
    v_add_f32 v69, v69, v89
    v_add_f32 v109, v109, v129
    v_add_f32 v70, v70, v90
    v_add_f32 v110, v110, v130
    v_add_f32 v71, v71, v91
    v_add_f32 v111, v111, v131
    v_add_f32 v68, v68, v108
    v_add_f32 v69, v69, v109
    v_add_f32 v70, v70, v110
    v_add_f32 v71, v71, v111
    v_add_f32 v72, v72, v92
    v_add_f32 v112, v112, v132
    v_add_f32 v73, v73, v93
    v_add_f32 v113, v113, v133
    v_add_f32 v74, v74, v94
    v_add_f32 v114, v114, v134
    v_add_f32 v75, v75, v95
    v_add_f32 v115, v115, v135
    v_add_f32 v72, v72, v112
    v_add_f32 v73, v73, v113
    v_add_f32 v74, v74, v114
    v_add_f32 v75, v75, v115
    v_add_f32 v76, v76, v96
    s_waitcnt lgkmcnt(0)
    v_add_f32 v116, v116, v136
    v_add_f32 v77, v77, v97
    v_add_f32 v117, v117, v137
    v_add_f32 v78, v78, v98
    v_add_f32 v118, v118, v138
    v_add_f32 v79, v79, v99
    v_add_f32 v119, v119, v139
    v_add_f32 v76, v76, v116
    v_add_f32 v77, v77, v117
    v_add_f32 v78, v78, v118
    v_add_f32 v79, v79, v119
    v_add_f32 v80, v80, v100
    v_add_f32 v120, v120, v140
    v_add_f32 v81, v81, v101
    v_add_f32 v121, v121, v141
    v_add_f32 v82, v82, v102
    v_add_f32 v122, v122, v142
    v_add_f32 v83, v83, v103
    v_add_f32 v123, v123, v143
    v_add_f32 v80, v80, v120
    v_add_f32 v81, v81, v121
    v_add_f32 v82, v82, v122
    v_add_f32 v83, v83, v123
    v_cvt_pk_bf16_f32 v24, v64, v65
    v_cvt_pk_bf16_f32 v25, v66, v67
    v_cvt_pk_bf16_f32 v26, v68, v69
    v_cvt_pk_bf16_f32 v27, v70, v71
    v_cvt_pk_bf16_f32 v28, v72, v73
    v_cvt_pk_bf16_f32 v29, v74, v75
    v_cvt_pk_bf16_f32 v30, v76, v77
    v_cvt_pk_bf16_f32 v31, v78, v79
    v_cvt_pk_bf16_f32 v32, v80, v81
    v_cvt_pk_bf16_f32 v33, v82, v83
    buffer_store_dwordx4 v[24:27], v20, s[32:35], 0 offen
    buffer_store_dwordx4 v[28:31], v20, s[32:35], 0 offen offset:64
    buffer_store_dwordx2 v[32:33], v21, s[32:35], 0 offen offset:128
    s_mul_i32 s50, s45, 5120
    v_add_u32 v6, s50, v2
    v_add_u32 v7, 71680, v6
    ds_read_b128 v[160:163], v6 offset:0
    ds_read_b128 v[164:167], v6 offset:1024
    ds_read_b128 v[168:171], v6 offset:2048
    ds_read_b128 v[172:175], v6 offset:3072
    ds_read_b128 v[176:179], v6 offset:4096
    ds_read_b128 v[180:183], v6 offset:35840
    ds_read_b128 v[184:187], v6 offset:36864
    ds_read_b128 v[188:191], v6 offset:37888
    ds_read_b128 v[192:195], v6 offset:38912
    ds_read_b128 v[196:199], v6 offset:39936
    ds_read_b128 v[200:203], v7 offset:0
    ds_read_b128 v[204:207], v7 offset:1024
    ds_read_b128 v[208:211], v7 offset:2048
    ds_read_b128 v[212:215], v7 offset:3072
    ds_read_b128 v[216:219], v7 offset:4096
    ds_read_b128 v[220:223], v7 offset:35840
    ds_read_b128 v[224:227], v7 offset:36864
    ds_read_b128 v[228:231], v7 offset:37888
    ds_read_b128 v[232:235], v7 offset:38912
    ds_read_b128 v[236:239], v7 offset:39936
    s_lshl_b32 s51, s45, 4
    s_add_u32 s51, s51, s46
    v_add_u32 v19, s51, v4
    v_mul_lo_u32 v19, v19, s49
    v_add_u32 v19, s47, v19
    v_lshl_add_u32 v22, v3, 4, v19
    v_lshl_add_u32 v23, v3, 3, v19
    s_waitcnt lgkmcnt(2)
    v_add_f32 v160, v160, v180
    v_add_f32 v200, v200, v220
    v_add_f32 v161, v161, v181
    v_add_f32 v201, v201, v221
    v_add_f32 v162, v162, v182
    v_add_f32 v202, v202, v222
    v_add_f32 v163, v163, v183
    v_add_f32 v203, v203, v223
    v_add_f32 v160, v160, v200
    v_add_f32 v161, v161, v201
    v_add_f32 v162, v162, v202
    v_add_f32 v163, v163, v203
    v_add_f32 v164, v164, v184
    v_add_f32 v204, v204, v224
    v_add_f32 v165, v165, v185
    v_add_f32 v205, v205, v225
    v_add_f32 v166, v166, v186
    v_add_f32 v206, v206, v226
    v_add_f32 v167, v167, v187
    v_add_f32 v207, v207, v227
    v_add_f32 v164, v164, v204
    v_add_f32 v165, v165, v205
    v_add_f32 v166, v166, v206
    v_add_f32 v167, v167, v207
    v_add_f32 v168, v168, v188
    v_add_f32 v208, v208, v228
    v_add_f32 v169, v169, v189
    v_add_f32 v209, v209, v229
    v_add_f32 v170, v170, v190
    v_add_f32 v210, v210, v230
    v_add_f32 v171, v171, v191
    v_add_f32 v211, v211, v231
    v_add_f32 v168, v168, v208
    v_add_f32 v169, v169, v209
    v_add_f32 v170, v170, v210
    v_add_f32 v171, v171, v211
    v_add_f32 v172, v172, v192
    s_waitcnt lgkmcnt(0)
    v_add_f32 v212, v212, v232
    v_add_f32 v173, v173, v193
    v_add_f32 v213, v213, v233
    v_add_f32 v174, v174, v194
    v_add_f32 v214, v214, v234
    v_add_f32 v175, v175, v195
    v_add_f32 v215, v215, v235
    v_add_f32 v172, v172, v212
    v_add_f32 v173, v173, v213
    v_add_f32 v174, v174, v214
    v_add_f32 v175, v175, v215
    v_add_f32 v176, v176, v196
    v_add_f32 v216, v216, v236
    v_add_f32 v177, v177, v197
    v_add_f32 v217, v217, v237
    v_add_f32 v178, v178, v198
    v_add_f32 v218, v218, v238
    v_add_f32 v179, v179, v199
    v_add_f32 v219, v219, v239
    v_add_f32 v176, v176, v216
    v_add_f32 v177, v177, v217
    v_add_f32 v178, v178, v218
    v_add_f32 v179, v179, v219
    v_cvt_pk_bf16_f32 v36, v160, v161
    v_cvt_pk_bf16_f32 v37, v162, v163
    v_cvt_pk_bf16_f32 v38, v164, v165
    v_cvt_pk_bf16_f32 v39, v166, v167
    v_cvt_pk_bf16_f32 v40, v168, v169
    v_cvt_pk_bf16_f32 v41, v170, v171
    v_cvt_pk_bf16_f32 v42, v172, v173
    v_cvt_pk_bf16_f32 v43, v174, v175
    v_cvt_pk_bf16_f32 v44, v176, v177
    v_cvt_pk_bf16_f32 v45, v178, v179
    buffer_store_dwordx4 v[36:39], v22, s[32:35], 0 offen
    buffer_store_dwordx4 v[40:43], v22, s[32:35], 0 offen offset:64
    buffer_store_dwordx2 v[44:45], v23, s[32:35], 0 offen offset:128
    s_waitcnt vmcnt(0)
L_op_done:
    s_endpgm
.section .rodata,"a"
.p2align 6
.amdhsa_kernel attn_kernel
  .amdhsa_next_free_vgpr 512
  .amdhsa_next_free_sgpr 102
  .amdhsa_accum_offset 256
  .amdhsa_group_segment_fixed_size 0
  .amdhsa_kernarg_size 104
  .amdhsa_user_sgpr_count 2
  .amdhsa_user_sgpr_kernarg_segment_ptr 1
  .amdhsa_system_sgpr_workgroup_id_x 1
.end_amdhsa_kernel
.p2align 6
.amdhsa_kernel oproj_kernel
  .amdhsa_next_free_vgpr 400
  .amdhsa_next_free_sgpr 102
  .amdhsa_accum_offset 256
  .amdhsa_group_segment_fixed_size 0
  .amdhsa_kernarg_size 104
  .amdhsa_user_sgpr_count 2
  .amdhsa_user_sgpr_kernarg_segment_ptr 1
  .amdhsa_system_sgpr_workgroup_id_x 1
.end_amdhsa_kernel
```
